```python
import torch

def _softmax(x, axis=-1):
    return torch.softmax(x, dim=axis)
def _gelu(x):
    return torch.nn.functional.gelu(x, approximate="tanh")
def _silu(x):
    return torch.nn.functional.silu(x)
def _sigmoid(x):
    return torch.sigmoid(x)
def _layernorm(x, axis=-1, eps=1e-5):
    m = x.mean(dim=axis, keepdim=True)
    v = x.var(dim=axis, keepdim=True, unbiased=False)
    return (x - m) / torch.sqrt(v + eps)
def _scatter_add(tgt, idx, src, axis=0):
    return tgt.clone().index_add_(axis, idx, src)
def _segment_sum(src, seg, n):
    out = torch.zeros((n,) + src.shape[1:], dtype=src.dtype)
    return out.index_add_(0, seg, src)
def _pad(x, pw):
    flat = tuple(v for pair in reversed(pw) for v in pair)
    return torch.nn.functional.pad(x, flat)

kernel_name = 'standalone__gqa_block_cached__near_ridge'

def setup_inputs():

    _w = (lambda a: (lambda t: t.to(torch.bfloat16) if t.is_floating_point() else t)(torch.as_tensor(a)))
    B, Sq, D = 8, 96, 512
    Hq, Hkv, Sk, Dh = 32, 32, 1024, 128
    assert Hq % Hkv == 0, (Hq, Hkv)
    return {
        "x": _w((lambda *s: torch.randn(*s, dtype=torch.bfloat16) * 0.8)(B, Sq, D)),
        "k_cache": _w((lambda *s: torch.randn(*s, dtype=torch.bfloat16) * 0.8)(B, Hkv, Sk, Dh)),
        "v_cache": _w((lambda *s: torch.randn(*s, dtype=torch.bfloat16) * 0.05)(B, Hkv, Sk, Dh)),
        "wq": _w((lambda *s: torch.randn(*s, dtype=torch.bfloat16) * 0.8)(D, Hq * Dh) * (D ** -0.5)),
        "wo": _w((lambda *s: torch.randn(*s, dtype=torch.bfloat16) * 0.05)(Hq * Dh, D) * ((Hq * Dh) ** -0.5)),
    }

def reference(x, k_cache, v_cache, wq, wo):
    B, Sq, D = x.shape
    Hq, Dh = 32, 128
    Hkv = k_cache.shape[1]
    rep = Hq // Hkv
    q = (lambda x, *d: x.permute(*d))((x @ wq).reshape(B, Sq, Hq, Dh), 0, 2, 1, 3)
    k = (lambda x, n, axis: torch.repeat_interleave(x, n, dim=axis))(k_cache, rep, axis=1)
    v = (lambda x, n, axis: torch.repeat_interleave(x, n, dim=axis))(v_cache, rep, axis=1)
    scores = torch.einsum("bhqd,bhkd->bhqk", q, k) * (Dh ** -0.5)
    p = _softmax(scores, axis=-1)
    o = torch.einsum("bhqk,bhkd->bhqd", p, v)
    return (lambda x, *d: x.permute(*d))(o, 0, 2, 1, 3).reshape(B, Sq, Hq * Dh) @ wo
```

```asm
; @launch grid=(256,1,1) block=(256,1,1) lds=163840
.amdgcn_target "amdgcn-amd-amdhsa--gfx950"
.text
.globl standalone__gqa_block_cached__near_ridge_kernel
.p2align 8
.type standalone__gqa_block_cached__near_ridge_kernel,@function
standalone__gqa_block_cached__near_ridge_kernel:
    s_cmp_ge_u32 s2, 256
    s_cbranch_scc1 L_end
    s_load_dwordx16 s[4:19], s[0:1], 0
    s_getpc_b64 s[96:97]
L_pc_ref:
    v_lshrrev_b32 v2, 6, v0
    v_and_b32 v0, 63, v0
    v_readfirstlane_b32 s3, v2
    s_and_b32 s62, s2, 7
    s_lshr_b32 s63, s2, 3
    s_lshl_b32 s57, s62, 2
    s_and_b32 s73, s63, 3
    s_add_u32 s57, s57, s73
    s_lshr_b32 s56, s63, 2
    s_lshl_b32 s58, s56, 5
    s_add_u32 s58, s58, s57
    s_movk_i32 s74, 0x1000
    v_and_b32 v4, 15, v0
    v_lshrrev_b32 v5, 4, v0
    v_lshrrev_b32 v6, 5, v0
    v_and_b32 v7, 31, v0
    v_lshlrev_b32 v1, 4, v0
    v_lshlrev_b32 v8, 2, v5
    v_xor_b32 v8, v4, v8
    v_lshlrev_b32 v8, 4, v8
    s_lshl_b32 s73, s57, 8
    v_mov_b32 v12, 163776
    s_cmp_eq_u32 s3, 3
    s_cbranch_scc1 L_helper
    v_lshl_add_u32 v232, v5, 13, v8
    v_add_u32 v233, 95232, v232
    v_lshrrev_b32 v9, 3, v0
    v_and_b32 v10, 7, v0
    v_xor_b32 v10, v10, v5
    v_lshlrev_b32 v10, 4, v10
    v_lshl_add_u32 v224, v9, 10, v10
    v_xor_b32 v225, 64, v224
    v_add_u32 v225, 7168, v225
    v_add_u32 v226, 14336, v224
    v_add_u32 v227, 14336, v225
    s_lshl_b32 s75, s3, 15
    s_lshl_b32 s66, s3, 12
    s_lshl_b32 s68, s3, 10
    s_lshl_b32 s79, s57, 1
    s_add_u32 s79, s79, s56
    s_and_b32 s79, s79, 7
    s_lshl_b32 s76, s79, 19
    s_add_u32 s75, s75, s76
    s_lshl_b32 s79, s79, 7
    s_mul_i32 s69, s56, 98304
    s_lshl_b32 s76, s3, 15
    s_add_u32 s69, s69, s76
    s_waitcnt lgkmcnt(0)
    s_add_u32 s32, s10, s73
    s_addc_u32 s33, s11, 0
    s_sub_u32 s34, 0x400000, s73
    s_mov_b32 s35, 0x20000
    s_add_u32 s20, s4, s69
    s_addc_u32 s21, s5, 0
    s_mov_b32 s22, 0x8000
    s_mov_b32 s23, 0x20000
    s_lshl_b32 s73, s2, 14
    s_add_u32 s24, s12, s73
    s_addc_u32 s25, s13, 0
    s_movk_i32 s26, 0x4000
    s_mov_b32 s27, 0x20000
    s_add_u32 m0, s68, 49152
    s_mov_b32 s65, s68
    buffer_load_dwordx4 v1, s[24:27], s65 offen  lds
    s_add_u32 m0, m0, 3072
    s_add_u32 s65, s65, 3072
    buffer_load_dwordx4 v1, s[24:27], s65 offen  lds
    s_add_u32 m0, m0, 3072
    s_add_u32 s65, s65, 3072
    buffer_load_dwordx4 v1, s[24:27], s65 offen  lds
    s_add_u32 m0, m0, 3072
    s_add_u32 s65, s65, 3072
    buffer_load_dwordx4 v1, s[24:27], s65 offen  lds
    s_add_u32 m0, m0, 3072
    s_add_u32 s65, s65, 3072
    buffer_load_dwordx4 v1, s[24:27], s65 offen  lds
    s_add_u32 m0, m0, 3072
    s_add_u32 s65, s65, 3072
    s_cmp_lg_u32 s3, 0
    s_cbranch_scc1 L_wops
    buffer_load_dwordx4 v1, s[24:27], s65 offen  lds
L_wops:
    s_add_u32 m0, m0, 3072
    s_add_u32 s65, s65, 3072
    s_add_u32 m0, s66, 114688
    s_nop 0
    buffer_load_dwordx4 v224, s[20:23], s79 offen offset:0  lds
    buffer_load_dwordx4 v225, s[20:23], s79 offen offset:1024  lds
    buffer_load_dwordx4 v226, s[20:23], s79 offen offset:2048  lds
    buffer_load_dwordx4 v227, s[20:23], s79 offen offset:3072  lds
    s_add_u32 m0, s68, 65536
    s_add_u32 s79, s79, 128
    s_and_b32 s79, s79, 1023
    buffer_load_dwordx4 v232, s[32:35], s75 offen offset:0  lds
    buffer_load_dwordx4 v233, s[32:35], s75 offen offset:3072  lds
    s_add_u32 m0, m0, 6144
    s_add_u32 s75, s75, 196608
    buffer_load_dwordx4 v232, s[32:35], s75 offen offset:0  lds
    buffer_load_dwordx4 v233, s[32:35], s75 offen offset:3072  lds
    s_add_u32 m0, m0, 6144
    s_add_u32 s75, s75, 196608
    buffer_load_dwordx4 v232, s[32:35], s75 offen offset:0  lds
    s_cmp_lg_u32 s3, 0
    s_cbranch_scc1 L_cqs0
    buffer_load_dwordx4 v233, s[32:35], s75 offen offset:3072  lds
L_cqs0:
    s_add_u32 m0, m0, 6144
    s_add_u32 s75, s75, 196608
    s_sub_u32 s75, s75, 65536
    s_and_b32 s75, s75, 0x3fffff
    s_add_u32 m0, s66, 126976
    s_nop 0
    buffer_load_dwordx4 v224, s[20:23], s79 offen offset:0  lds
    buffer_load_dwordx4 v225, s[20:23], s79 offen offset:1024  lds
    buffer_load_dwordx4 v226, s[20:23], s79 offen offset:2048  lds
    buffer_load_dwordx4 v227, s[20:23], s79 offen offset:3072  lds
    s_add_u32 m0, s68, 81920
    s_add_u32 s79, s79, 128
    s_and_b32 s79, s79, 1023
    buffer_load_dwordx4 v232, s[32:35], s75 offen offset:0  lds
    buffer_load_dwordx4 v233, s[32:35], s75 offen offset:3072  lds
    s_add_u32 m0, m0, 6144
    s_add_u32 s75, s75, 196608
    buffer_load_dwordx4 v232, s[32:35], s75 offen offset:0  lds
    buffer_load_dwordx4 v233, s[32:35], s75 offen offset:3072  lds
    s_add_u32 m0, m0, 6144
    s_add_u32 s75, s75, 196608
    buffer_load_dwordx4 v232, s[32:35], s75 offen offset:0  lds
    s_cmp_lg_u32 s3, 0
    s_cbranch_scc1 L_cqs1
    buffer_load_dwordx4 v233, s[32:35], s75 offen offset:3072  lds
L_cqs1:
    s_add_u32 m0, m0, 6144
    s_add_u32 s75, s75, 196608
    s_sub_u32 s75, s75, 65536
    s_and_b32 s75, s75, 0x3fffff
    v_xor_b32 v13, v6, v4
    v_lshlrev_b32 v13, 4, v13
    v_lshl_add_u32 v253, v7, 8, v13
    v_bfe_u32 v13, v0, 1, 3
    v_xor_b32 v13, v13, v6
    v_lshlrev_b32 v13, 4, v13
    v_lshl_add_u32 v13, v7, 7, v13
    s_lshl_b32 s73, s3, 12
    s_add_u32 s73, s73, 114688
    v_add_u32 v112, s73, v13
    v_xor_b32 v113, 32, v112
    v_xor_b32 v114, 64, v112
    v_xor_b32 v115, 96, v112
    v_bfe_u32 v9, v0, 2, 2
    v_and_b32 v10, 1, v5
    v_and_b32 v11, 3, v0
    v_lshlrev_b32 v14, 6, v9
    v_lshl_add_u32 v14, v10, 5, v14
    v_lshl_add_u32 v13, v6, 2, v9
    v_lshl_add_u32 v13, v13, 8, v14
    v_lshl_add_u32 v248, v11, 3, v13
    v_add_u32 v248, 32768, v248
    v_xor_b32 v249, 64, v248
    v_xor_b32 v250, 128, v248
    v_xor_b32 v251, 192, v248
    v_and_b32 v13, 1, v11
    v_lshlrev_b32 v13, 1, v13
    v_lshrrev_b32 v8, 1, v11
    v_or_b32 v13, v13, v8
    v_lshl_add_u32 v8, v6, 3, v9
    v_lshl_add_u32 v8, v8, 8, v14
    v_lshl_add_u32 v8, v13, 3, v8
    v_add_u32 v240, 65536, v8
    v_xor_b32 v241, 64, v240
    v_xor_b32 v242, 128, v240
    v_xor_b32 v243, 192, v240
    v_lshrrev_b32 v13, 4, v7
    v_lshlrev_b32 v13, 12, v13
    v_lshl_add_u32 v13, v6, 8, v13
    v_lshl_add_u32 v13, v4, 4, v13
    s_lshl_b32 s73, s3, 13
    v_add_u32 v252, s73, v13
    s_mov_b32 s67, 0x3e0293ee
    s_mov_b32 s100, 0x45800000
    v_lshl_add_u32 v116, v10, 2, v9
    v_lshlrev_b32 v116, 10, v116
    v_lshl_add_u32 v116, v6, 5, v116
    v_lshl_add_u32 v116, v11, 3, v116
    s_lshl_b32 s73, s3, 6
    s_add_u32 s73, s73, 49152
    v_add_u32 v116, s73, v116
    v_lshlrev_b32 v117, 10, v6
    v_lshl_add_u32 v117, v10, 8, v117
    v_lshl_add_u32 v117, v4, 4, v117
    s_and_b32 s59, s62, 1
    s_lshl_b32 s59, s59, 3
    s_and_b32 s73, s63, 7
    s_add_u32 s59, s59, s73
    s_lshr_b32 s60, s62, 1
    s_lshl_b32 s60, s60, 2
    s_lshr_b32 s73, s63, 3
    s_add_u32 s60, s60, s73
    s_lshr_b32 s61, s59, 1
    s_lshl_b32 s73, s3, 16
    s_lshl_b32 s76, s60, 18
    s_add_u32 s73, s73, s76
    s_add_u32 s73, s73, 8388608
    s_add_u32 s36, s18, s73
    s_addc_u32 s37, s19, 0
    s_lshl_b32 s73, s3, 16
    s_sub_u32 s38, 0x40000, s73
    s_mov_b32 s39, 0x20000
    s_lshl_b32 s76, s60, 6
    s_mul_i32 s73, s59, 49152
    s_add_u32 s73, s73, s76
    s_add_u32 s40, s14, s73
    s_addc_u32 s41, s15, 0
    s_sub_u32 s42, 49152, s76
    s_mov_b32 s43, 0x20000
    s_mul_i32 s73, s58, 24576
    s_add_u32 s44, s18, s73
    s_addc_u32 s45, s19, 0
    s_movk_i32 s46, 24576
    s_mov_b32 s47, 0x20000
    s_lshl_b32 s73, s61, 5
    s_lshl_b32 s76, s3, 3
    s_add_u32 s73, s73, s76
    s_mul_i32 s73, s73, 24576
    s_and_b32 s76, s59, 1
    s_mul_i32 s76, s76, 12288
    s_add_u32 s73, s73, s76
    s_add_u32 s48, s18, s73
    s_addc_u32 s49, s19, 0
    s_mov_b32 s50, 184320
    s_mov_b32 s51, 0x20000
    s_mov_b32 s52, s16
    s_mov_b32 s53, s17
    s_movk_i32 s54, 256
    s_mov_b32 s55, 0x20000
    s_add_u32 s4, s18, 12599296
    s_addc_u32 s5, s19, 0
    s_movk_i32 s6, 1024
    s_mov_b32 s7, 0x20000
    s_mov_b32 s72, 200000
    s_mov_b32 s70, 0
    s_and_b32 s77, s63, 7
    s_lshl_b32 s77, s77, 2
    s_lshr_b32 s77, 0x54732160, s77
    s_and_b32 s77, s77, 7
    s_mul_i32 s77, s77, 3
    s_lshr_b32 s77, s77, 1
    s_add_u32 s77, s77, 2
    s_mov_b32 s101, 0
    s_lshl_b32 s73, s3, 2
    s_add_u32 s73, s73, 163792
    v_mov_b32 v13, s73
    s_lshr_b32 s73, s2, 1
    s_lshl_b32 s73, s73, 11
    s_and_b32 s76, s2, 1
    s_lshl_b32 s76, s76, 9
    s_add_u32 s73, s73, s76
    s_sub_u32 s90, 0x400000, s73
    s_add_u32 s73, s73, 8388608
    s_add_u32 s88, s18, s73
    s_addc_u32 s89, s19, 0
    s_mov_b32 s91, 0x20000
    s_barrier
    s_waitcnt vmcnt(18) lgkmcnt(0)
    v_mov_b32 v14, 1
    ds_write_b32 v13, v14 offset:16
L_qs0:
    ds_read_b128 v[160:163], v12 offset:32
    s_waitcnt lgkmcnt(0)
    v_min3_u32 v160, v160, v161, v162
    s_nop 0
    v_readfirstlane_b32 s73, v160
    s_nop 0
    s_cmp_ge_u32 s73, 1
    s_cbranch_scc1 L_qs0_ok
    s_sub_u32 s72, s72, 1
    s_cbranch_scc0 L_qs0
    s_mov_b32 s72, 0
L_qs0_ok:
    ds_read_b64_tr_b16 v[192:193], v116 offset:0
    ds_read_b64_tr_b16 v[194:195], v116 offset:8192
    ds_read_b64_tr_b16 v[196:197], v116 offset:192
    ds_read_b64_tr_b16 v[198:199], v116 offset:8384
    ds_read_b64_tr_b16 v[200:201], v116 offset:384
    ds_read_b64_tr_b16 v[202:203], v116 offset:8576
    ds_read_b64_tr_b16 v[204:205], v116 offset:576
    ds_read_b64_tr_b16 v[206:207], v116 offset:8768
    ds_read_b64_tr_b16 v[208:209], v116 offset:768
    ds_read_b64_tr_b16 v[210:211], v116 offset:8960
    ds_read_b64_tr_b16 v[212:213], v116 offset:960
    ds_read_b64_tr_b16 v[214:215], v116 offset:9152
    s_lshl_b32 s76, s3, 18
    s_waitcnt lgkmcnt(0)
    buffer_store_dwordx4 v[192:195], v117, s[88:91], s76 offen sc1
    s_add_u32 s76, s76, 786432
    buffer_store_dwordx4 v[196:199], v117, s[88:91], s76 offen sc1
    s_add_u32 s76, s76, 786432
    buffer_store_dwordx4 v[200:203], v117, s[88:91], s76 offen sc1
    s_add_u32 s76, s76, 786432
    buffer_store_dwordx4 v[204:207], v117, s[88:91], s76 offen sc1
    s_add_u32 s76, s76, 786432
    buffer_store_dwordx4 v[208:211], v117, s[88:91], s76 offen sc1
    s_add_u32 s76, s76, 786432
    buffer_store_dwordx4 v[212:215], v117, s[88:91], s76 offen sc1
    s_add_u32 s76, s76, 786432
    v_mov_b32 v8, 0
    buffer_load_dword v3, v8, s[52:55], 0 offen sc1
    s_add_u32 m0, s66, 139264
    s_nop 0
    buffer_load_dwordx4 v224, s[20:23], s79 offen offset:0  lds
    buffer_load_dwordx4 v225, s[20:23], s79 offen offset:1024  lds
    buffer_load_dwordx4 v226, s[20:23], s79 offen offset:2048  lds
    buffer_load_dwordx4 v227, s[20:23], s79 offen offset:3072  lds
    s_add_u32 m0, s68, 98304
    s_add_u32 s79, s79, 128
    s_and_b32 s79, s79, 1023
    buffer_load_dwordx4 v232, s[32:35], s75 offen offset:0  lds
    buffer_load_dwordx4 v233, s[32:35], s75 offen offset:3072  lds
    s_add_u32 m0, m0, 6144
    s_add_u32 s75, s75, 196608
    buffer_load_dwordx4 v232, s[32:35], s75 offen offset:0  lds
    buffer_load_dwordx4 v233, s[32:35], s75 offen offset:3072  lds
    s_add_u32 m0, m0, 6144
    s_add_u32 s75, s75, 196608
    buffer_load_dwordx4 v232, s[32:35], s75 offen offset:0  lds
    s_cmp_lg_u32 s3, 0
    s_cbranch_scc1 L_cqs2
    buffer_load_dwordx4 v233, s[32:35], s75 offen offset:3072  lds
L_cqs2:
    s_add_u32 m0, m0, 6144
    s_add_u32 s75, s75, 196608
    s_sub_u32 s75, s75, 65536
    s_and_b32 s75, s75, 0x3fffff
    s_waitcnt vmcnt(25) lgkmcnt(0)
    v_mov_b32 v14, 2
    ds_write_b32 v13, v14 offset:16
L_qs1:
    ds_read_b128 v[160:163], v12 offset:32
    s_waitcnt lgkmcnt(0)
    v_min3_u32 v160, v160, v161, v162
    s_nop 0
    v_readfirstlane_b32 s73, v160
    s_nop 0
    s_cmp_ge_u32 s73, 2
    s_cbranch_scc1 L_qs1_ok
    s_sub_u32 s72, s72, 1
    s_cbranch_scc0 L_qs1
    s_mov_b32 s72, 0
L_qs1_ok:
    ds_read_b128 a[64:67], v112 offset:0
    ds_read_b64_tr_b16 a[0:1], v240 offset:0
    ds_read_b64_tr_b16 a[2:3], v240 offset:1024
    ds_read_b64_tr_b16 a[4:5], v241 offset:0
    ds_read_b64_tr_b16 a[6:7], v241 offset:1024
    ds_read_b64_tr_b16 a[8:9], v242 offset:0
    ds_read_b64_tr_b16 a[10:11], v242 offset:1024
    ds_read_b64_tr_b16 a[12:13], v243 offset:0
    ds_read_b64_tr_b16 a[14:15], v243 offset:1024
    ds_read_b128 a[68:71], v113 offset:0
    ds_read_b64_tr_b16 a[16:17], v240 offset:4096
    ds_read_b64_tr_b16 a[18:19], v240 offset:5120
    ds_read_b64_tr_b16 a[20:21], v241 offset:4096
    ds_read_b64_tr_b16 a[22:23], v241 offset:5120
    ds_read_b64_tr_b16 a[24:25], v242 offset:4096
    ds_read_b64_tr_b16 a[26:27], v242 offset:5120
    ds_read_b64_tr_b16 a[28:29], v243 offset:4096
    ds_read_b64_tr_b16 a[30:31], v243 offset:5120
    ds_read_b128 a[72:75], v114 offset:0
    ds_read_b64_tr_b16 a[32:33], v240 offset:8192
    ds_read_b64_tr_b16 a[34:35], v240 offset:9216
    ds_read_b64_tr_b16 a[36:37], v241 offset:8192
    ds_read_b64_tr_b16 a[38:39], v241 offset:9216
    ds_read_b64_tr_b16 a[40:41], v242 offset:8192
    ds_read_b64_tr_b16 a[42:43], v242 offset:9216
    ds_read_b64_tr_b16 a[44:45], v243 offset:8192
    ds_read_b64_tr_b16 a[46:47], v243 offset:9216
    ds_read_b128 a[76:79], v115 offset:0
    ds_read_b64_tr_b16 a[48:49], v240 offset:12288
    ds_read_b64_tr_b16 a[50:51], v240 offset:13312
    ds_read_b64_tr_b16 a[52:53], v241 offset:12288
    ds_read_b64_tr_b16 a[54:55], v241 offset:13312
    ds_read_b64_tr_b16 a[56:57], v242 offset:12288
    ds_read_b64_tr_b16 a[58:59], v242 offset:13312
    ds_read_b64_tr_b16 a[60:61], v243 offset:12288
    ds_read_b64_tr_b16 a[62:63], v243 offset:13312
    s_waitcnt vmcnt(16) lgkmcnt(0)
    v_mov_b32 v14, 3
    ds_write_b32 v13, v14 offset:16
L_qs2:
    ds_read_b128 v[160:163], v12 offset:32
    s_waitcnt lgkmcnt(0)
    v_min3_u32 v160, v160, v161, v162
    s_nop 0
    v_readfirstlane_b32 s73, v160
    s_nop 0
    s_cmp_ge_u32 s73, 3
    s_cbranch_scc1 L_qs2_ok
    s_sub_u32 s72, s72, 1
    s_cbranch_scc0 L_qs2
    s_mov_b32 s72, 0
L_qs2_ok:
    v_mfma_f32_32x32x16_bf16 v[48:63], a[0:3], a[64:67], 0
    ds_read_b128 a[144:147], v112 offset:12288
    ds_read_b64_tr_b16 a[80:81], v240 offset:16384
    ds_read_b64_tr_b16 a[82:83], v240 offset:17408
    s_add_u32 m0, s66, 114688
    s_nop 0
    buffer_load_dwordx4 v224, s[20:23], s79 offen offset:0  lds
    v_mfma_f32_32x32x16_bf16 v[64:79], a[4:7], a[64:67], 0
    ds_read_b64_tr_b16 a[84:85], v241 offset:16384
    ds_read_b64_tr_b16 a[86:87], v241 offset:17408
    ds_read_b64_tr_b16 a[88:89], v242 offset:16384
    buffer_load_dwordx4 v225, s[20:23], s79 offen offset:1024  lds
    v_mfma_f32_32x32x16_bf16 v[80:95], a[8:11], a[64:67], 0
    ds_read_b64_tr_b16 a[90:91], v242 offset:17408
    ds_read_b64_tr_b16 a[92:93], v243 offset:16384
    ds_read_b64_tr_b16 a[94:95], v243 offset:17408
    buffer_load_dwordx4 v226, s[20:23], s79 offen offset:2048  lds
    v_mfma_f32_32x32x16_bf16 v[96:111], a[12:15], a[64:67], 0
    ds_read_b128 a[148:151], v113 offset:12288
    ds_read_b64_tr_b16 a[96:97], v240 offset:20480
    ds_read_b64_tr_b16 a[98:99], v240 offset:21504
    buffer_load_dwordx4 v227, s[20:23], s79 offen offset:3072  lds
    v_mfma_f32_32x32x16_bf16 v[48:63], a[16:19], a[68:71], v[48:63]
    ds_read_b64_tr_b16 a[100:101], v241 offset:20480
    ds_read_b64_tr_b16 a[102:103], v241 offset:21504
    ds_read_b64_tr_b16 a[104:105], v242 offset:20480
    s_add_u32 m0, s68, 65536
    s_add_u32 s79, s79, 128
    s_and_b32 s79, s79, 1023
    v_mfma_f32_32x32x16_bf16 v[64:79], a[20:23], a[68:71], v[64:79]
    ds_read_b64_tr_b16 a[106:107], v242 offset:21504
    ds_read_b64_tr_b16 a[108:109], v243 offset:20480
    ds_read_b64_tr_b16 a[110:111], v243 offset:21504
    buffer_load_dwordx4 v232, s[32:35], s75 offen offset:0  lds
    v_mfma_f32_32x32x16_bf16 v[80:95], a[24:27], a[68:71], v[80:95]
    ds_read_b128 a[152:155], v114 offset:12288
    ds_read_b64_tr_b16 a[112:113], v240 offset:24576
    ds_read_b64_tr_b16 a[114:115], v240 offset:25600
    buffer_load_dwordx4 v233, s[32:35], s75 offen offset:3072  lds
    v_mfma_f32_32x32x16_bf16 v[96:111], a[28:31], a[68:71], v[96:111]
    ds_read_b64_tr_b16 a[116:117], v241 offset:24576
    ds_read_b64_tr_b16 a[118:119], v241 offset:25600
    ds_read_b64_tr_b16 a[120:121], v242 offset:24576
    s_add_u32 m0, m0, 6144
    s_add_u32 s75, s75, 196608
    v_mfma_f32_32x32x16_bf16 v[48:63], a[32:35], a[72:75], v[48:63]
    ds_read_b64_tr_b16 a[122:123], v242 offset:25600
    ds_read_b64_tr_b16 a[124:125], v243 offset:24576
    ds_read_b64_tr_b16 a[126:127], v243 offset:25600
    buffer_load_dwordx4 v232, s[32:35], s75 offen offset:0  lds
    v_mfma_f32_32x32x16_bf16 v[64:79], a[36:39], a[72:75], v[64:79]
    ds_read_b128 a[156:159], v115 offset:12288
    ds_read_b64_tr_b16 a[128:129], v240 offset:28672
    ds_read_b64_tr_b16 a[130:131], v240 offset:29696
    buffer_load_dwordx4 v233, s[32:35], s75 offen offset:3072  lds
    v_mfma_f32_32x32x16_bf16 v[80:95], a[40:43], a[72:75], v[80:95]
    ds_read_b64_tr_b16 a[132:133], v241 offset:28672
    ds_read_b64_tr_b16 a[134:135], v241 offset:29696
    ds_read_b64_tr_b16 a[136:137], v242 offset:28672
    s_add_u32 m0, m0, 6144
    s_add_u32 s75, s75, 196608
    v_mfma_f32_32x32x16_bf16 v[96:111], a[44:47], a[72:75], v[96:111]
    ds_read_b64_tr_b16 a[138:139], v242 offset:29696
    ds_read_b64_tr_b16 a[140:141], v243 offset:28672
    ds_read_b64_tr_b16 a[142:143], v243 offset:29696
    buffer_load_dwordx4 v232, s[32:35], s75 offen offset:0  lds
    v_mfma_f32_32x32x16_bf16 v[48:63], a[48:51], a[76:79], v[48:63]
    s_cmp_lg_u32 s3, 0
    s_cbranch_scc1 L_cqs3
    buffer_load_dwordx4 v233, s[32:35], s75 offen offset:3072  lds
L_cqs3:
    v_mfma_f32_32x32x16_bf16 v[64:79], a[52:55], a[76:79], v[64:79]
    s_add_u32 m0, m0, 6144
    s_add_u32 s75, s75, 196608
    v_mfma_f32_32x32x16_bf16 v[80:95], a[56:59], a[76:79], v[80:95]
    s_sub_u32 s75, s75, 65536
    s_and_b32 s75, s75, 0x3fffff
    v_mfma_f32_32x32x16_bf16 v[96:111], a[60:63], a[76:79], v[96:111]
    s_waitcnt vmcnt(9) lgkmcnt(0)
    v_mov_b32 v14, 4
    ds_write_b32 v13, v14 offset:16
L_qs3:
    ds_read_b128 v[160:163], v12 offset:32
    s_waitcnt lgkmcnt(0)
    v_min3_u32 v160, v160, v161, v162
    s_nop 0
    v_readfirstlane_b32 s73, v160
    s_nop 0
    s_cmp_ge_u32 s73, 4
    s_cbranch_scc1 L_qs3_ok
    s_sub_u32 s72, s72, 1
    s_cbranch_scc0 L_qs3
    s_mov_b32 s72, 0
L_qs3_ok:
    s_call_b64 s[94:95], L_getep0
    v_mov_b32 v7, s78
    ds_write_b32 v12, v7 offset:48
    s_call_b64 s[94:95], L_side0
    v_mfma_f32_32x32x16_bf16 v[48:63], a[80:83], a[144:147], v[48:63]
    ds_read_b128 a[64:67], v112 offset:24576
    ds_read_b64_tr_b16 a[0:1], v240 offset:32768
    ds_read_b64_tr_b16 a[2:3], v240 offset:33792
    s_add_u32 m0, s66, 126976
    s_nop 0
    buffer_load_dwordx4 v224, s[20:23], s79 offen offset:0  lds
    v_mfma_f32_32x32x16_bf16 v[64:79], a[84:87], a[144:147], v[64:79]
    ds_read_b64_tr_b16 a[4:5], v241 offset:32768
    ds_read_b64_tr_b16 a[6:7], v241 offset:33792
    ds_read_b64_tr_b16 a[8:9], v242 offset:32768
    buffer_load_dwordx4 v225, s[20:23], s79 offen offset:1024  lds
    v_mfma_f32_32x32x16_bf16 v[80:95], a[88:91], a[144:147], v[80:95]
    ds_read_b64_tr_b16 a[10:11], v242 offset:33792
    ds_read_b64_tr_b16 a[12:13], v243 offset:32768
    ds_read_b64_tr_b16 a[14:15], v243 offset:33792
    buffer_load_dwordx4 v226, s[20:23], s79 offen offset:2048  lds
    v_mfma_f32_32x32x16_bf16 v[96:111], a[92:95], a[144:147], v[96:111]
    ds_read_b128 a[68:71], v113 offset:24576
    ds_read_b64_tr_b16 a[16:17], v240 offset:36864
    ds_read_b64_tr_b16 a[18:19], v240 offset:37888
    buffer_load_dwordx4 v227, s[20:23], s79 offen offset:3072  lds
    v_mfma_f32_32x32x16_bf16 v[48:63], a[96:99], a[148:151], v[48:63]
    ds_read_b64_tr_b16 a[20:21], v241 offset:36864
    ds_read_b64_tr_b16 a[22:23], v241 offset:37888
    ds_read_b64_tr_b16 a[24:25], v242 offset:36864
    s_add_u32 m0, s68, 81920
    s_add_u32 s79, s79, 128
    s_and_b32 s79, s79, 1023
    v_mfma_f32_32x32x16_bf16 v[64:79], a[100:103], a[148:151], v[64:79]
    ds_read_b64_tr_b16 a[26:27], v242 offset:37888
    ds_read_b64_tr_b16 a[28:29], v243 offset:36864
    ds_read_b64_tr_b16 a[30:31], v243 offset:37888
    buffer_load_dwordx4 v232, s[32:35], s75 offen offset:0  lds
    v_mfma_f32_32x32x16_bf16 v[80:95], a[104:107], a[148:151], v[80:95]
    ds_read_b128 a[72:75], v114 offset:24576
    ds_read_b64_tr_b16 a[32:33], v240 offset:40960
    ds_read_b64_tr_b16 a[34:35], v240 offset:41984
    buffer_load_dwordx4 v233, s[32:35], s75 offen offset:3072  lds
    v_mfma_f32_32x32x16_bf16 v[96:111], a[108:111], a[148:151], v[96:111]
    ds_read_b64_tr_b16 a[36:37], v241 offset:40960
    ds_read_b64_tr_b16 a[38:39], v241 offset:41984
    ds_read_b64_tr_b16 a[40:41], v242 offset:40960
    s_add_u32 m0, m0, 6144
    s_add_u32 s75, s75, 196608
    v_mfma_f32_32x32x16_bf16 v[48:63], a[112:115], a[152:155], v[48:63]
    ds_read_b64_tr_b16 a[42:43], v242 offset:41984
    ds_read_b64_tr_b16 a[44:45], v243 offset:40960
    ds_read_b64_tr_b16 a[46:47], v243 offset:41984
    buffer_load_dwordx4 v232, s[32:35], s75 offen offset:0  lds
    v_mfma_f32_32x32x16_bf16 v[64:79], a[116:119], a[152:155], v[64:79]
    ds_read_b128 a[76:79], v115 offset:24576
    ds_read_b64_tr_b16 a[48:49], v240 offset:45056
    ds_read_b64_tr_b16 a[50:51], v240 offset:46080
    buffer_load_dwordx4 v233, s[32:35], s75 offen offset:3072  lds
    v_mfma_f32_32x32x16_bf16 v[80:95], a[120:123], a[152:155], v[80:95]
    ds_read_b64_tr_b16 a[52:53], v241 offset:45056
    ds_read_b64_tr_b16 a[54:55], v241 offset:46080
    ds_read_b64_tr_b16 a[56:57], v242 offset:45056
    s_add_u32 m0, m0, 6144
    s_add_u32 s75, s75, 196608
    v_mfma_f32_32x32x16_bf16 v[96:111], a[124:127], a[152:155], v[96:111]
    ds_read_b64_tr_b16 a[58:59], v242 offset:46080
    ds_read_b64_tr_b16 a[60:61], v243 offset:45056
    ds_read_b64_tr_b16 a[62:63], v243 offset:46080
    buffer_load_dwordx4 v232, s[32:35], s75 offen offset:0  lds
    v_mfma_f32_32x32x16_bf16 v[48:63], a[128:131], a[156:159], v[48:63]
    s_cmp_lg_u32 s3, 0
    s_cbranch_scc1 L_cqs4
    buffer_load_dwordx4 v233, s[32:35], s75 offen offset:3072  lds
L_cqs4:
    v_mfma_f32_32x32x16_bf16 v[64:79], a[132:135], a[156:159], v[64:79]
    s_add_u32 m0, m0, 6144
    s_add_u32 s75, s75, 196608
    v_mfma_f32_32x32x16_bf16 v[80:95], a[136:139], a[156:159], v[80:95]
    s_sub_u32 s75, s75, 65536
    s_and_b32 s75, s75, 0x3fffff
    v_mfma_f32_32x32x16_bf16 v[96:111], a[140:143], a[156:159], v[96:111]
    s_waitcnt vmcnt(9) lgkmcnt(0)
    v_mov_b32 v14, 5
    ds_write_b32 v13, v14 offset:16
L_qs4:
    ds_read_b128 v[160:163], v12 offset:32
    s_waitcnt lgkmcnt(0)
    v_min3_u32 v160, v160, v161, v162
    s_nop 0
    v_readfirstlane_b32 s73, v160
    s_nop 0
    s_cmp_ge_u32 s73, 5
    s_cbranch_scc1 L_qs4_ok
    s_sub_u32 s72, s72, 1
    s_cbranch_scc0 L_qs4
    s_mov_b32 s72, 0
L_qs4_ok:
    v_mfma_f32_32x32x16_bf16 v[48:63], a[0:3], a[64:67], v[48:63]
    ds_read_b128 a[144:147], v112 offset:0
    ds_read_b64_tr_b16 a[80:81], v240 offset:0
    ds_read_b64_tr_b16 a[82:83], v240 offset:1024
    s_add_u32 m0, s66, 139264
    s_nop 0
    buffer_load_dwordx4 v224, s[20:23], s79 offen offset:0  lds
    v_mfma_f32_32x32x16_bf16 v[64:79], a[4:7], a[64:67], v[64:79]
    ds_read_b64_tr_b16 a[84:85], v241 offset:0
    ds_read_b64_tr_b16 a[86:87], v241 offset:1024
    ds_read_b64_tr_b16 a[88:89], v242 offset:0
    buffer_load_dwordx4 v225, s[20:23], s79 offen offset:1024  lds
    v_mfma_f32_32x32x16_bf16 v[80:95], a[8:11], a[64:67], v[80:95]
    ds_read_b64_tr_b16 a[90:91], v242 offset:1024
    ds_read_b64_tr_b16 a[92:93], v243 offset:0
    ds_read_b64_tr_b16 a[94:95], v243 offset:1024
    buffer_load_dwordx4 v226, s[20:23], s79 offen offset:2048  lds
    v_mfma_f32_32x32x16_bf16 v[96:111], a[12:15], a[64:67], v[96:111]
    ds_read_b128 a[148:151], v113 offset:0
    ds_read_b64_tr_b16 a[96:97], v240 offset:4096
    ds_read_b64_tr_b16 a[98:99], v240 offset:5120
    buffer_load_dwordx4 v227, s[20:23], s79 offen offset:3072  lds
    v_mfma_f32_32x32x16_bf16 v[48:63], a[16:19], a[68:71], v[48:63]
    ds_read_b64_tr_b16 a[100:101], v241 offset:4096
    ds_read_b64_tr_b16 a[102:103], v241 offset:5120
    ds_read_b64_tr_b16 a[104:105], v242 offset:4096
    s_add_u32 m0, s68, 98304
    s_add_u32 s79, s79, 128
    s_and_b32 s79, s79, 1023
    v_mfma_f32_32x32x16_bf16 v[64:79], a[20:23], a[68:71], v[64:79]
    ds_read_b64_tr_b16 a[106:107], v242 offset:5120
    ds_read_b64_tr_b16 a[108:109], v243 offset:4096
    ds_read_b64_tr_b16 a[110:111], v243 offset:5120
    buffer_load_dwordx4 v232, s[32:35], s75 offen offset:0  lds
    v_mfma_f32_32x32x16_bf16 v[80:95], a[24:27], a[68:71], v[80:95]
    ds_read_b128 a[152:155], v114 offset:0
    ds_read_b64_tr_b16 a[112:113], v240 offset:8192
    ds_read_b64_tr_b16 a[114:115], v240 offset:9216
    buffer_load_dwordx4 v233, s[32:35], s75 offen offset:3072  lds
    v_mfma_f32_32x32x16_bf16 v[96:111], a[28:31], a[68:71], v[96:111]
    ds_read_b64_tr_b16 a[116:117], v241 offset:8192
    ds_read_b64_tr_b16 a[118:119], v241 offset:9216
    ds_read_b64_tr_b16 a[120:121], v242 offset:8192
    s_add_u32 m0, m0, 6144
    s_add_u32 s75, s75, 196608
    v_mfma_f32_32x32x16_bf16 v[48:63], a[32:35], a[72:75], v[48:63]
    ds_read_b64_tr_b16 a[122:123], v242 offset:9216
    ds_read_b64_tr_b16 a[124:125], v243 offset:8192
    ds_read_b64_tr_b16 a[126:127], v243 offset:9216
    buffer_load_dwordx4 v232, s[32:35], s75 offen offset:0  lds
    v_mfma_f32_32x32x16_bf16 v[64:79], a[36:39], a[72:75], v[64:79]
    ds_read_b128 a[156:159], v115 offset:0
    ds_read_b64_tr_b16 a[128:129], v240 offset:12288
    ds_read_b64_tr_b16 a[130:131], v240 offset:13312
    buffer_load_dwordx4 v233, s[32:35], s75 offen offset:3072  lds
    v_mfma_f32_32x32x16_bf16 v[80:95], a[40:43], a[72:75], v[80:95]
    ds_read_b64_tr_b16 a[132:133], v241 offset:12288
    ds_read_b64_tr_b16 a[134:135], v241 offset:13312
    ds_read_b64_tr_b16 a[136:137], v242 offset:12288
    s_add_u32 m0, m0, 6144
    s_add_u32 s75, s75, 196608
    v_mfma_f32_32x32x16_bf16 v[96:111], a[44:47], a[72:75], v[96:111]
    ds_read_b64_tr_b16 a[138:139], v242 offset:13312
    ds_read_b64_tr_b16 a[140:141], v243 offset:12288
    ds_read_b64_tr_b16 a[142:143], v243 offset:13312
    buffer_load_dwordx4 v232, s[32:35], s75 offen offset:0  lds
    v_mfma_f32_32x32x16_bf16 v[48:63], a[48:51], a[76:79], v[48:63]
    s_cmp_lg_u32 s3, 0
    s_cbranch_scc1 L_cqs5
    buffer_load_dwordx4 v233, s[32:35], s75 offen offset:3072  lds
L_cqs5:
    v_mfma_f32_32x32x16_bf16 v[64:79], a[52:55], a[76:79], v[64:79]
    s_add_u32 m0, m0, 6144
    s_add_u32 s75, s75, 196608
    v_mfma_f32_32x32x16_bf16 v[80:95], a[56:59], a[76:79], v[80:95]
    s_sub_u32 s75, s75, 65536
    s_and_b32 s75, s75, 0x3fffff
    v_mfma_f32_32x32x16_bf16 v[96:111], a[60:63], a[76:79], v[96:111]
    s_waitcnt vmcnt(9) lgkmcnt(0)
    v_mov_b32 v14, 6
    ds_write_b32 v13, v14 offset:16
L_qs5:
    ds_read_b128 v[160:163], v12 offset:32
    s_waitcnt lgkmcnt(0)
    v_min3_u32 v160, v160, v161, v162
    s_nop 0
    v_readfirstlane_b32 s73, v160
    s_nop 0
    s_cmp_ge_u32 s73, 6
    s_cbranch_scc1 L_qs5_ok
    s_sub_u32 s72, s72, 1
    s_cbranch_scc0 L_qs5
    s_mov_b32 s72, 0
L_qs5_ok:
    v_mfma_f32_32x32x16_bf16 v[48:63], a[80:83], a[144:147], v[48:63]
    ds_read_b128 a[64:67], v112 offset:12288
    ds_read_b64_tr_b16 a[0:1], v240 offset:16384
    ds_read_b64_tr_b16 a[2:3], v240 offset:17408
    s_add_u32 m0, s66, 114688
    s_nop 0
    buffer_load_dwordx4 v224, s[20:23], s79 offen offset:0  lds
    v_mfma_f32_32x32x16_bf16 v[64:79], a[84:87], a[144:147], v[64:79]
    ds_read_b64_tr_b16 a[4:5], v241 offset:16384
    ds_read_b64_tr_b16 a[6:7], v241 offset:17408
    ds_read_b64_tr_b16 a[8:9], v242 offset:16384
    buffer_load_dwordx4 v225, s[20:23], s79 offen offset:1024  lds
    v_mfma_f32_32x32x16_bf16 v[80:95], a[88:91], a[144:147], v[80:95]
    ds_read_b64_tr_b16 a[10:11], v242 offset:17408
    ds_read_b64_tr_b16 a[12:13], v243 offset:16384
    ds_read_b64_tr_b16 a[14:15], v243 offset:17408
    buffer_load_dwordx4 v226, s[20:23], s79 offen offset:2048  lds
    v_mfma_f32_32x32x16_bf16 v[96:111], a[92:95], a[144:147], v[96:111]
    ds_read_b128 a[68:71], v113 offset:12288
    ds_read_b64_tr_b16 a[16:17], v240 offset:20480
    ds_read_b64_tr_b16 a[18:19], v240 offset:21504
    buffer_load_dwordx4 v227, s[20:23], s79 offen offset:3072  lds
    v_mfma_f32_32x32x16_bf16 v[48:63], a[96:99], a[148:151], v[48:63]
    ds_read_b64_tr_b16 a[20:21], v241 offset:20480
    ds_read_b64_tr_b16 a[22:23], v241 offset:21504
    ds_read_b64_tr_b16 a[24:25], v242 offset:20480
    s_add_u32 m0, s68, 65536
    s_add_u32 s79, s79, 128
    s_and_b32 s79, s79, 1023
    v_mfma_f32_32x32x16_bf16 v[64:79], a[100:103], a[148:151], v[64:79]
    ds_read_b64_tr_b16 a[26:27], v242 offset:21504
    ds_read_b64_tr_b16 a[28:29], v243 offset:20480
    ds_read_b64_tr_b16 a[30:31], v243 offset:21504
    buffer_load_dwordx4 v232, s[32:35], s75 offen offset:0  lds
    v_mfma_f32_32x32x16_bf16 v[80:95], a[104:107], a[148:151], v[80:95]
    ds_read_b128 a[72:75], v114 offset:12288
    ds_read_b64_tr_b16 a[32:33], v240 offset:24576
    ds_read_b64_tr_b16 a[34:35], v240 offset:25600
    buffer_load_dwordx4 v233, s[32:35], s75 offen offset:3072  lds
    v_mfma_f32_32x32x16_bf16 v[96:111], a[108:111], a[148:151], v[96:111]
    ds_read_b64_tr_b16 a[36:37], v241 offset:24576
    ds_read_b64_tr_b16 a[38:39], v241 offset:25600
    ds_read_b64_tr_b16 a[40:41], v242 offset:24576
    s_add_u32 m0, m0, 6144
    s_add_u32 s75, s75, 196608
    v_mfma_f32_32x32x16_bf16 v[48:63], a[112:115], a[152:155], v[48:63]
    ds_read_b64_tr_b16 a[42:43], v242 offset:25600
    ds_read_b64_tr_b16 a[44:45], v243 offset:24576
    ds_read_b64_tr_b16 a[46:47], v243 offset:25600
    buffer_load_dwordx4 v232, s[32:35], s75 offen offset:0  lds
    v_mfma_f32_32x32x16_bf16 v[64:79], a[116:119], a[152:155], v[64:79]
    ds_read_b128 a[76:79], v115 offset:12288
    ds_read_b64_tr_b16 a[48:49], v240 offset:28672
    ds_read_b64_tr_b16 a[50:51], v240 offset:29696
    buffer_load_dwordx4 v233, s[32:35], s75 offen offset:3072  lds
    v_mfma_f32_32x32x16_bf16 v[80:95], a[120:123], a[152:155], v[80:95]
    ds_read_b64_tr_b16 a[52:53], v241 offset:28672
    ds_read_b64_tr_b16 a[54:55], v241 offset:29696
    ds_read_b64_tr_b16 a[56:57], v242 offset:28672
    s_add_u32 m0, m0, 6144
    s_add_u32 s75, s75, 196608
    v_mfma_f32_32x32x16_bf16 v[96:111], a[124:127], a[152:155], v[96:111]
    ds_read_b64_tr_b16 a[58:59], v242 offset:29696
    ds_read_b64_tr_b16 a[60:61], v243 offset:28672
    ds_read_b64_tr_b16 a[62:63], v243 offset:29696
    buffer_load_dwordx4 v232, s[32:35], s75 offen offset:0  lds
    v_mfma_f32_32x32x16_bf16 v[48:63], a[128:131], a[156:159], v[48:63]
    s_cmp_lg_u32 s3, 0
    s_cbranch_scc1 L_cqs6
    buffer_load_dwordx4 v233, s[32:35], s75 offen offset:3072  lds
L_cqs6:
    v_mfma_f32_32x32x16_bf16 v[64:79], a[132:135], a[156:159], v[64:79]
    s_add_u32 m0, m0, 6144
    s_add_u32 s75, s75, 196608
    v_mfma_f32_32x32x16_bf16 v[80:95], a[136:139], a[156:159], v[80:95]
    s_sub_u32 s75, s75, 65536
    s_and_b32 s75, s75, 0x3fffff
    v_mfma_f32_32x32x16_bf16 v[96:111], a[140:143], a[156:159], v[96:111]
    s_waitcnt vmcnt(9) lgkmcnt(0)
    v_mov_b32 v14, 7
    ds_write_b32 v13, v14 offset:16
L_qs6:
    ds_read_b128 v[160:163], v12 offset:32
    s_waitcnt lgkmcnt(0)
    v_min3_u32 v160, v160, v161, v162
    s_nop 0
    v_readfirstlane_b32 s73, v160
    s_nop 0
    s_cmp_ge_u32 s73, 7
    s_cbranch_scc1 L_qs6_ok
    s_sub_u32 s72, s72, 1
    s_cbranch_scc0 L_qs6
    s_mov_b32 s72, 0
L_qs6_ok:
    v_mfma_f32_32x32x16_bf16 v[48:63], a[0:3], a[64:67], v[48:63]
    ds_read_b128 a[144:147], v112 offset:24576
    ds_read_b64_tr_b16 a[80:81], v240 offset:32768
    ds_read_b64_tr_b16 a[82:83], v240 offset:33792
    s_add_u32 m0, s66, 126976
    s_nop 0
    buffer_load_dwordx4 v224, s[20:23], s79 offen offset:0  lds
    v_mfma_f32_32x32x16_bf16 v[64:79], a[4:7], a[64:67], v[64:79]
    ds_read_b64_tr_b16 a[84:85], v241 offset:32768
    ds_read_b64_tr_b16 a[86:87], v241 offset:33792
    ds_read_b64_tr_b16 a[88:89], v242 offset:32768
    buffer_load_dwordx4 v225, s[20:23], s79 offen offset:1024  lds
    v_mfma_f32_32x32x16_bf16 v[80:95], a[8:11], a[64:67], v[80:95]
    ds_read_b64_tr_b16 a[90:91], v242 offset:33792
    ds_read_b64_tr_b16 a[92:93], v243 offset:32768
    ds_read_b64_tr_b16 a[94:95], v243 offset:33792
    buffer_load_dwordx4 v226, s[20:23], s79 offen offset:2048  lds
    v_mfma_f32_32x32x16_bf16 v[96:111], a[12:15], a[64:67], v[96:111]
    ds_read_b128 a[148:151], v113 offset:24576
    ds_read_b64_tr_b16 a[96:97], v240 offset:36864
    ds_read_b64_tr_b16 a[98:99], v240 offset:37888
    buffer_load_dwordx4 v227, s[20:23], s79 offen offset:3072  lds
    v_mfma_f32_32x32x16_bf16 v[48:63], a[16:19], a[68:71], v[48:63]
    ds_read_b64_tr_b16 a[100:101], v241 offset:36864
    ds_read_b64_tr_b16 a[102:103], v241 offset:37888
    ds_read_b64_tr_b16 a[104:105], v242 offset:36864
    s_add_u32 m0, s68, 81920
    s_add_u32 s79, s79, 128
    s_and_b32 s79, s79, 1023
    v_mfma_f32_32x32x16_bf16 v[64:79], a[20:23], a[68:71], v[64:79]
    ds_read_b64_tr_b16 a[106:107], v242 offset:37888
    ds_read_b64_tr_b16 a[108:109], v243 offset:36864
    ds_read_b64_tr_b16 a[110:111], v243 offset:37888
    buffer_load_dwordx4 v232, s[32:35], s75 offen offset:0  lds
    v_mfma_f32_32x32x16_bf16 v[80:95], a[24:27], a[68:71], v[80:95]
    ds_read_b128 a[152:155], v114 offset:24576
    ds_read_b64_tr_b16 a[112:113], v240 offset:40960
    ds_read_b64_tr_b16 a[114:115], v240 offset:41984
    buffer_load_dwordx4 v233, s[32:35], s75 offen offset:3072  lds
    v_mfma_f32_32x32x16_bf16 v[96:111], a[28:31], a[68:71], v[96:111]
    ds_read_b64_tr_b16 a[116:117], v241 offset:40960
    ds_read_b64_tr_b16 a[118:119], v241 offset:41984
    ds_read_b64_tr_b16 a[120:121], v242 offset:40960
    s_add_u32 m0, m0, 6144
    s_add_u32 s75, s75, 196608
    v_mfma_f32_32x32x16_bf16 v[48:63], a[32:35], a[72:75], v[48:63]
    ds_read_b64_tr_b16 a[122:123], v242 offset:41984
    ds_read_b64_tr_b16 a[124:125], v243 offset:40960
    ds_read_b64_tr_b16 a[126:127], v243 offset:41984
    buffer_load_dwordx4 v232, s[32:35], s75 offen offset:0  lds
    v_mfma_f32_32x32x16_bf16 v[64:79], a[36:39], a[72:75], v[64:79]
    ds_read_b128 a[156:159], v115 offset:24576
    ds_read_b64_tr_b16 a[128:129], v240 offset:45056
    ds_read_b64_tr_b16 a[130:131], v240 offset:46080
    buffer_load_dwordx4 v233, s[32:35], s75 offen offset:3072  lds
    v_mfma_f32_32x32x16_bf16 v[80:95], a[40:43], a[72:75], v[80:95]
    ds_read_b64_tr_b16 a[132:133], v241 offset:45056
    ds_read_b64_tr_b16 a[134:135], v241 offset:46080
    ds_read_b64_tr_b16 a[136:137], v242 offset:45056
    s_add_u32 m0, m0, 6144
    s_add_u32 s75, s75, 196608
    v_mfma_f32_32x32x16_bf16 v[96:111], a[44:47], a[72:75], v[96:111]
    ds_read_b64_tr_b16 a[138:139], v242 offset:46080
    ds_read_b64_tr_b16 a[140:141], v243 offset:45056
    ds_read_b64_tr_b16 a[142:143], v243 offset:46080
    buffer_load_dwordx4 v232, s[32:35], s75 offen offset:0  lds
    v_mfma_f32_32x32x16_bf16 v[48:63], a[48:51], a[76:79], v[48:63]
    s_cmp_lg_u32 s3, 0
    s_cbranch_scc1 L_cqs7
    buffer_load_dwordx4 v233, s[32:35], s75 offen offset:3072  lds
L_cqs7:
    v_mfma_f32_32x32x16_bf16 v[64:79], a[52:55], a[76:79], v[64:79]
    s_add_u32 m0, m0, 6144
    s_add_u32 s75, s75, 196608
    v_mfma_f32_32x32x16_bf16 v[80:95], a[56:59], a[76:79], v[80:95]
    s_sub_u32 s75, s75, 65536
    s_and_b32 s75, s75, 0x3fffff
    v_mfma_f32_32x32x16_bf16 v[96:111], a[60:63], a[76:79], v[96:111]
    s_waitcnt vmcnt(9) lgkmcnt(0)
    v_mov_b32 v14, 8
    ds_write_b32 v13, v14 offset:16
L_qs7:
    ds_read_b128 v[160:163], v12 offset:32
    s_waitcnt lgkmcnt(0)
    v_min3_u32 v160, v160, v161, v162
    s_nop 0
    v_readfirstlane_b32 s73, v160
    s_nop 0
    s_cmp_ge_u32 s73, 8
    s_cbranch_scc1 L_qs7_ok
    s_sub_u32 s72, s72, 1
    s_cbranch_scc0 L_qs7
    s_mov_b32 s72, 0
L_qs7_ok:
    v_mfma_f32_32x32x16_bf16 v[48:63], a[80:83], a[144:147], v[48:63]
    ds_read_b128 a[64:67], v112 offset:0
    ds_read_b64_tr_b16 a[0:1], v240 offset:0
    ds_read_b64_tr_b16 a[2:3], v240 offset:1024
    v_mfma_f32_32x32x16_bf16 v[64:79], a[84:87], a[144:147], v[64:79]
    ds_read_b64_tr_b16 a[4:5], v241 offset:0
    ds_read_b64_tr_b16 a[6:7], v241 offset:1024
    ds_read_b64_tr_b16 a[8:9], v242 offset:0
    v_mfma_f32_32x32x16_bf16 v[80:95], a[88:91], a[144:147], v[80:95]
    ds_read_b64_tr_b16 a[10:11], v242 offset:1024
    ds_read_b64_tr_b16 a[12:13], v243 offset:0
    ds_read_b64_tr_b16 a[14:15], v243 offset:1024
    v_mfma_f32_32x32x16_bf16 v[96:111], a[92:95], a[144:147], v[96:111]
    ds_read_b128 a[68:71], v113 offset:0
    ds_read_b64_tr_b16 a[16:17], v240 offset:4096
    ds_read_b64_tr_b16 a[18:19], v240 offset:5120
    v_mfma_f32_32x32x16_bf16 v[48:63], a[96:99], a[148:151], v[48:63]
    ds_read_b64_tr_b16 a[20:21], v241 offset:4096
    ds_read_b64_tr_b16 a[22:23], v241 offset:5120
    ds_read_b64_tr_b16 a[24:25], v242 offset:4096
    v_mfma_f32_32x32x16_bf16 v[64:79], a[100:103], a[148:151], v[64:79]
    ds_read_b64_tr_b16 a[26:27], v242 offset:5120
    ds_read_b64_tr_b16 a[28:29], v243 offset:4096
    ds_read_b64_tr_b16 a[30:31], v243 offset:5120
    v_mfma_f32_32x32x16_bf16 v[80:95], a[104:107], a[148:151], v[80:95]
    ds_read_b128 a[72:75], v114 offset:0
    ds_read_b64_tr_b16 a[32:33], v240 offset:8192
    ds_read_b64_tr_b16 a[34:35], v240 offset:9216
    v_mfma_f32_32x32x16_bf16 v[96:111], a[108:111], a[148:151], v[96:111]
    ds_read_b64_tr_b16 a[36:37], v241 offset:8192
    ds_read_b64_tr_b16 a[38:39], v241 offset:9216
    ds_read_b64_tr_b16 a[40:41], v242 offset:8192
    v_mfma_f32_32x32x16_bf16 v[48:63], a[112:115], a[152:155], v[48:63]
    ds_read_b64_tr_b16 a[42:43], v242 offset:9216
    ds_read_b64_tr_b16 a[44:45], v243 offset:8192
    ds_read_b64_tr_b16 a[46:47], v243 offset:9216
    v_mfma_f32_32x32x16_bf16 v[64:79], a[116:119], a[152:155], v[64:79]
    ds_read_b128 a[76:79], v115 offset:0
    ds_read_b64_tr_b16 a[48:49], v240 offset:12288
    ds_read_b64_tr_b16 a[50:51], v240 offset:13312
    v_mfma_f32_32x32x16_bf16 v[80:95], a[120:123], a[152:155], v[80:95]
    ds_read_b64_tr_b16 a[52:53], v241 offset:12288
    ds_read_b64_tr_b16 a[54:55], v241 offset:13312
    ds_read_b64_tr_b16 a[56:57], v242 offset:12288
    v_mfma_f32_32x32x16_bf16 v[96:111], a[124:127], a[152:155], v[96:111]
    ds_read_b64_tr_b16 a[58:59], v242 offset:13312
    ds_read_b64_tr_b16 a[60:61], v243 offset:12288
    ds_read_b64_tr_b16 a[62:63], v243 offset:13312
    v_mfma_f32_32x32x16_bf16 v[48:63], a[128:131], a[156:159], v[48:63]
    v_mfma_f32_32x32x16_bf16 v[64:79], a[132:135], a[156:159], v[64:79]
    v_mfma_f32_32x32x16_bf16 v[80:95], a[136:139], a[156:159], v[80:95]
    v_mfma_f32_32x32x16_bf16 v[96:111], a[140:143], a[156:159], v[96:111]
    s_waitcnt vmcnt(0) lgkmcnt(0)
    v_mov_b32 v14, 9
    ds_write_b32 v13, v14 offset:16
L_qs8:
    ds_read_b128 v[160:163], v12 offset:32
    s_waitcnt lgkmcnt(0)
    v_min3_u32 v160, v160, v161, v162
    s_nop 0
    v_readfirstlane_b32 s73, v160
    s_nop 0
    s_cmp_ge_u32 s73, 9
    s_cbranch_scc1 L_qs8_ok
    s_sub_u32 s72, s72, 1
    s_cbranch_scc0 L_qs8
    s_mov_b32 s72, 0
L_qs8_ok:
    v_mfma_f32_32x32x16_bf16 v[48:63], a[0:3], a[64:67], v[48:63]
    ds_read_b128 a[144:147], v112 offset:12288
    ds_read_b64_tr_b16 a[80:81], v240 offset:16384
    ds_read_b64_tr_b16 a[82:83], v240 offset:17408
    v_mfma_f32_32x32x16_bf16 v[64:79], a[4:7], a[64:67], v[64:79]
    ds_read_b64_tr_b16 a[84:85], v241 offset:16384
    ds_read_b64_tr_b16 a[86:87], v241 offset:17408
    ds_read_b64_tr_b16 a[88:89], v242 offset:16384
    v_mfma_f32_32x32x16_bf16 v[80:95], a[8:11], a[64:67], v[80:95]
    ds_read_b64_tr_b16 a[90:91], v242 offset:17408
    ds_read_b64_tr_b16 a[92:93], v243 offset:16384
    ds_read_b64_tr_b16 a[94:95], v243 offset:17408
    v_mfma_f32_32x32x16_bf16 v[96:111], a[12:15], a[64:67], v[96:111]
    ds_read_b128 a[148:151], v113 offset:12288
    ds_read_b64_tr_b16 a[96:97], v240 offset:20480
    ds_read_b64_tr_b16 a[98:99], v240 offset:21504
    v_mfma_f32_32x32x16_bf16 v[48:63], a[16:19], a[68:71], v[48:63]
    ds_read_b64_tr_b16 a[100:101], v241 offset:20480
    ds_read_b64_tr_b16 a[102:103], v241 offset:21504
    ds_read_b64_tr_b16 a[104:105], v242 offset:20480
    v_mfma_f32_32x32x16_bf16 v[64:79], a[20:23], a[68:71], v[64:79]
    ds_read_b64_tr_b16 a[106:107], v242 offset:21504
    ds_read_b64_tr_b16 a[108:109], v243 offset:20480
    ds_read_b64_tr_b16 a[110:111], v243 offset:21504
    v_mfma_f32_32x32x16_bf16 v[80:95], a[24:27], a[68:71], v[80:95]
    ds_read_b128 a[152:155], v114 offset:12288
    ds_read_b64_tr_b16 a[112:113], v240 offset:24576
    ds_read_b64_tr_b16 a[114:115], v240 offset:25600
    v_mfma_f32_32x32x16_bf16 v[96:111], a[28:31], a[68:71], v[96:111]
    ds_read_b64_tr_b16 a[116:117], v241 offset:24576
    ds_read_b64_tr_b16 a[118:119], v241 offset:25600
    ds_read_b64_tr_b16 a[120:121], v242 offset:24576
    v_mfma_f32_32x32x16_bf16 v[48:63], a[32:35], a[72:75], v[48:63]
    ds_read_b64_tr_b16 a[122:123], v242 offset:25600
    ds_read_b64_tr_b16 a[124:125], v243 offset:24576
    ds_read_b64_tr_b16 a[126:127], v243 offset:25600
    v_mfma_f32_32x32x16_bf16 v[64:79], a[36:39], a[72:75], v[64:79]
    ds_read_b128 a[156:159], v115 offset:12288
    ds_read_b64_tr_b16 a[128:129], v240 offset:28672
    ds_read_b64_tr_b16 a[130:131], v240 offset:29696
    v_mfma_f32_32x32x16_bf16 v[80:95], a[40:43], a[72:75], v[80:95]
    ds_read_b64_tr_b16 a[132:133], v241 offset:28672
    ds_read_b64_tr_b16 a[134:135], v241 offset:29696
    ds_read_b64_tr_b16 a[136:137], v242 offset:28672
    v_mfma_f32_32x32x16_bf16 v[96:111], a[44:47], a[72:75], v[96:111]
    ds_read_b64_tr_b16 a[138:139], v242 offset:29696
    ds_read_b64_tr_b16 a[140:141], v243 offset:28672
    ds_read_b64_tr_b16 a[142:143], v243 offset:29696
    v_mfma_f32_32x32x16_bf16 v[48:63], a[48:51], a[76:79], v[48:63]
    v_mfma_f32_32x32x16_bf16 v[64:79], a[52:55], a[76:79], v[64:79]
    v_mfma_f32_32x32x16_bf16 v[80:95], a[56:59], a[76:79], v[80:95]
    v_mfma_f32_32x32x16_bf16 v[96:111], a[60:63], a[76:79], v[96:111]
    s_waitcnt lgkmcnt(0)
    v_mov_b32 v14, 1
    ds_write_b32 v13, v14
    v_mfma_f32_32x32x16_bf16 v[48:63], a[80:83], a[144:147], v[48:63]
    v_mfma_f32_32x32x16_bf16 v[64:79], a[84:87], a[144:147], v[64:79]
    v_mfma_f32_32x32x16_bf16 v[80:95], a[88:91], a[144:147], v[80:95]
    v_mfma_f32_32x32x16_bf16 v[96:111], a[92:95], a[144:147], v[96:111]
    v_mfma_f32_32x32x16_bf16 v[48:63], a[96:99], a[148:151], v[48:63]
    v_mfma_f32_32x32x16_bf16 v[64:79], a[100:103], a[148:151], v[64:79]
    v_mfma_f32_32x32x16_bf16 v[80:95], a[104:107], a[148:151], v[80:95]
    v_mfma_f32_32x32x16_bf16 v[96:111], a[108:111], a[148:151], v[96:111]
    v_mfma_f32_32x32x16_bf16 v[48:63], a[112:115], a[152:155], v[48:63]
    v_mfma_f32_32x32x16_bf16 v[64:79], a[116:119], a[152:155], v[64:79]
    v_mfma_f32_32x32x16_bf16 v[80:95], a[120:123], a[152:155], v[80:95]
    v_mfma_f32_32x32x16_bf16 v[96:111], a[124:127], a[152:155], v[96:111]
    v_mfma_f32_32x32x16_bf16 v[48:63], a[128:131], a[156:159], v[48:63]
    v_mfma_f32_32x32x16_bf16 v[64:79], a[132:135], a[156:159], v[64:79]
    v_mfma_f32_32x32x16_bf16 v[80:95], a[136:139], a[156:159], v[80:95]
    v_mfma_f32_32x32x16_bf16 v[96:111], a[140:143], a[156:159], v[96:111]
    s_lshl_b32 s73, s58, 4
    s_add_u32 s73, s73, 12582912
    s_add_u32 s28, s18, s73
    s_addc_u32 s29, s19, 0
    s_mov_b32 s30, 4
    s_mov_b32 s31, 0x20000
    v_xor_b32 v240, 0, v253
    v_xor_b32 v241, 32, v253
    v_xor_b32 v242, 64, v253
    v_xor_b32 v243, 96, v253
    v_xor_b32 v244, 128, v253
    v_xor_b32 v245, 160, v253
    v_xor_b32 v246, 192, v253
    v_xor_b32 v247, 224, v253
    v_mov_b32 v2, 0xff7fffff
    v_mov_b32 v3, 0
    s_mov_b32 s64, -1
    s_movk_i32 s65, 0x4000
    s_mov_b32 s66, 0x8000
    s_mov_b32 s71, 1
    ds_read_b32 v254, v12
    v_mul_f32 v48, s67, v48
    v_mul_f32 v49, s67, v49
    v_mul_f32 v50, s67, v50
    v_mul_f32 v51, s67, v51
    v_mul_f32 v52, s67, v52
    v_mul_f32 v53, s67, v53
    v_mul_f32 v54, s67, v54
    v_mul_f32 v55, s67, v55
    v_mul_f32 v56, s67, v56
    v_mul_f32 v57, s67, v57
    v_mul_f32 v58, s67, v58
    v_mul_f32 v59, s67, v59
    v_mul_f32 v60, s67, v60
    v_mul_f32 v61, s67, v61
    v_mul_f32 v62, s67, v62
    v_mul_f32 v63, s67, v63
    v_mul_f32 v64, s67, v64
    v_mul_f32 v65, s67, v65
    v_mul_f32 v66, s67, v66
    v_mul_f32 v67, s67, v67
    v_mul_f32 v68, s67, v68
    v_mul_f32 v69, s67, v69
    v_mul_f32 v70, s67, v70
    v_mul_f32 v71, s67, v71
    v_mul_f32 v72, s67, v72
    v_mul_f32 v73, s67, v73
    v_mul_f32 v74, s67, v74
    v_mul_f32 v75, s67, v75
    v_mul_f32 v76, s67, v76
    v_mul_f32 v77, s67, v77
    v_mul_f32 v78, s67, v78
    v_mul_f32 v79, s67, v79
    v_mul_f32 v80, s67, v80
    v_mul_f32 v81, s67, v81
    v_mul_f32 v82, s67, v82
    v_mul_f32 v83, s67, v83
    v_mul_f32 v84, s67, v84
    v_mul_f32 v85, s67, v85
    v_mul_f32 v86, s67, v86
    v_mul_f32 v87, s67, v87
    v_mul_f32 v88, s67, v88
    v_mul_f32 v89, s67, v89
    v_mul_f32 v90, s67, v90
    v_mul_f32 v91, s67, v91
    v_mul_f32 v92, s67, v92
    v_mul_f32 v93, s67, v93
    v_mul_f32 v94, s67, v94
    v_mul_f32 v95, s67, v95
    v_mul_f32 v96, s67, v96
    v_mul_f32 v97, s67, v97
    v_mul_f32 v98, s67, v98
    v_mul_f32 v99, s67, v99
    v_mul_f32 v100, s67, v100
    v_mul_f32 v101, s67, v101
    v_mul_f32 v102, s67, v102
    v_mul_f32 v103, s67, v103
    v_mul_f32 v104, s67, v104
    v_mul_f32 v105, s67, v105
    v_mul_f32 v106, s67, v106
    v_mul_f32 v107, s67, v107
    v_mul_f32 v108, s67, v108
    v_mul_f32 v109, s67, v109
    v_mul_f32 v110, s67, v110
    v_mul_f32 v111, s67, v111
    v_cvt_pk_bf16_f32 v16, v48, v49
    v_cvt_pk_bf16_f32 v17, v50, v51
    v_cvt_pk_bf16_f32 v18, v52, v53
    v_cvt_pk_bf16_f32 v19, v54, v55
    v_cvt_pk_bf16_f32 v20, v56, v57
    v_cvt_pk_bf16_f32 v21, v58, v59
    v_cvt_pk_bf16_f32 v22, v60, v61
    v_cvt_pk_bf16_f32 v23, v62, v63
    v_cvt_pk_bf16_f32 v24, v64, v65
    v_cvt_pk_bf16_f32 v25, v66, v67
    v_cvt_pk_bf16_f32 v26, v68, v69
    v_cvt_pk_bf16_f32 v27, v70, v71
    v_cvt_pk_bf16_f32 v28, v72, v73
    v_cvt_pk_bf16_f32 v29, v74, v75
    v_cvt_pk_bf16_f32 v30, v76, v77
    v_cvt_pk_bf16_f32 v31, v78, v79
    v_cvt_pk_bf16_f32 v32, v80, v81
    v_cvt_pk_bf16_f32 v33, v82, v83
    v_cvt_pk_bf16_f32 v34, v84, v85
    v_cvt_pk_bf16_f32 v35, v86, v87
    v_cvt_pk_bf16_f32 v36, v88, v89
    v_cvt_pk_bf16_f32 v37, v90, v91
    v_cvt_pk_bf16_f32 v38, v92, v93
    v_cvt_pk_bf16_f32 v39, v94, v95
    v_cvt_pk_bf16_f32 v40, v96, v97
    v_cvt_pk_bf16_f32 v41, v98, v99
    v_cvt_pk_bf16_f32 v42, v100, v101
    v_cvt_pk_bf16_f32 v43, v102, v103
    v_cvt_pk_bf16_f32 v44, v104, v105
    v_cvt_pk_bf16_f32 v45, v106, v107
    v_cvt_pk_bf16_f32 v46, v108, v109
    v_cvt_pk_bf16_f32 v47, v110, v111
L_wlp:
    s_waitcnt lgkmcnt(0)
    v_readfirstlane_b32 s73, v254
    s_nop 0
    s_cmp_ge_u32 s73, s71
    s_cbranch_scc1 L_wlp_ok
    s_sub_u32 s72, s72, 1
    s_cbranch_scc1 L_wlp_giveup
    s_sleep 1
    ds_read_b32 v254, v12
    s_branch L_wlp
L_wlp_giveup:
    s_mov_b32 s72, 0
L_wlp_ok:
    ds_read_b128 v[160:163], v240 offset:0
    ds_read_b128 v[164:167], v241 offset:0
    ds_read_b128 v[168:171], v242 offset:0
    ds_read_b128 v[172:175], v243 offset:0
    ds_read_b128 v[176:179], v244 offset:0
    ds_read_b128 v[180:183], v245 offset:0
    ds_read_b128 v[184:187], v246 offset:0
    ds_read_b128 v[188:191], v247 offset:0
    s_waitcnt lgkmcnt(7)
    v_mfma_f32_32x32x16_bf16 v[112:127], v[160:163], v[16:19], 0
    ds_read_b128 v[160:163], v240 offset:8192
    v_mov_b32 v48, 0
    v_mov_b32 v49, 0
    v_mov_b32 v50, 0
    v_mov_b32 v51, 0
    v_mov_b32 v52, 0
    s_waitcnt lgkmcnt(7)
    v_mfma_f32_32x32x16_bf16 v[112:127], v[164:167], v[20:23], v[112:127]
    ds_read_b128 v[164:167], v241 offset:8192
    v_mov_b32 v53, 0
    v_mov_b32 v54, 0
    v_mov_b32 v55, 0
    v_mov_b32 v56, 0
    v_mov_b32 v57, 0
    s_waitcnt lgkmcnt(7)
    v_mfma_f32_32x32x16_bf16 v[112:127], v[168:171], v[24:27], v[112:127]
    ds_read_b128 v[168:171], v242 offset:8192
    v_mov_b32 v58, 0
    v_mov_b32 v59, 0
    v_mov_b32 v60, 0
    v_mov_b32 v61, 0
    v_mov_b32 v62, 0
    s_waitcnt lgkmcnt(7)
    v_mfma_f32_32x32x16_bf16 v[112:127], v[172:175], v[28:31], v[112:127]
    ds_read_b128 v[172:175], v243 offset:8192
    v_mov_b32 v63, 0
    v_mov_b32 v64, 0
    v_mov_b32 v65, 0
    v_mov_b32 v66, 0
    v_mov_b32 v67, 0
    s_waitcnt lgkmcnt(7)
    v_mfma_f32_32x32x16_bf16 v[112:127], v[176:179], v[32:35], v[112:127]
    ds_read_b128 v[176:179], v244 offset:8192
    v_mov_b32 v68, 0
    v_mov_b32 v69, 0
    v_mov_b32 v70, 0
    v_mov_b32 v71, 0
    v_mov_b32 v72, 0
    s_waitcnt lgkmcnt(7)
    v_mfma_f32_32x32x16_bf16 v[112:127], v[180:183], v[36:39], v[112:127]
    ds_read_b128 v[180:183], v245 offset:8192
    v_mov_b32 v73, 0
    v_mov_b32 v74, 0
    v_mov_b32 v75, 0
    v_mov_b32 v76, 0
    v_mov_b32 v77, 0
    s_waitcnt lgkmcnt(7)
    v_mfma_f32_32x32x16_bf16 v[112:127], v[184:187], v[40:43], v[112:127]
    ds_read_b128 v[184:187], v246 offset:8192
    v_mov_b32 v78, 0
    v_mov_b32 v79, 0
    v_mov_b32 v80, 0
    v_mov_b32 v81, 0
    v_mov_b32 v82, 0
    s_waitcnt lgkmcnt(7)
    v_mfma_f32_32x32x16_bf16 v[112:127], v[188:191], v[44:47], v[112:127]
    ds_read_b128 v[188:191], v247 offset:8192
    v_mov_b32 v83, 0
    v_mov_b32 v84, 0
    v_mov_b32 v85, 0
    v_mov_b32 v86, 0
    v_mov_b32 v87, 0
    s_waitcnt lgkmcnt(7)
    v_mfma_f32_32x32x16_bf16 v[128:143], v[160:163], v[16:19], 0
    v_mov_b32 v88, 0
    v_mov_b32 v89, 0
    v_mov_b32 v90, 0
    v_mov_b32 v91, 0
    s_waitcnt lgkmcnt(6)
    v_mfma_f32_32x32x16_bf16 v[128:143], v[164:167], v[20:23], v[128:143]
    v_mov_b32 v92, 0
    v_mov_b32 v93, 0
    v_mov_b32 v94, 0
    v_mov_b32 v95, 0
    s_waitcnt lgkmcnt(5)
    v_mfma_f32_32x32x16_bf16 v[128:143], v[168:171], v[24:27], v[128:143]
    v_mov_b32 v96, 0
    v_mov_b32 v97, 0
    v_mov_b32 v98, 0
    v_mov_b32 v99, 0
    s_waitcnt lgkmcnt(4)
    v_mfma_f32_32x32x16_bf16 v[128:143], v[172:175], v[28:31], v[128:143]
    v_mov_b32 v100, 0
    v_mov_b32 v101, 0
    v_mov_b32 v102, 0
    v_mov_b32 v103, 0
    s_waitcnt lgkmcnt(3)
    v_mfma_f32_32x32x16_bf16 v[128:143], v[176:179], v[32:35], v[128:143]
    v_mov_b32 v104, 0
    v_mov_b32 v105, 0
    v_mov_b32 v106, 0
    v_mov_b32 v107, 0
    s_waitcnt lgkmcnt(2)
    v_mfma_f32_32x32x16_bf16 v[128:143], v[180:183], v[36:39], v[128:143]
    v_mov_b32 v108, 0
    v_mov_b32 v109, 0
    v_mov_b32 v110, 0
    v_mov_b32 v111, 0
    s_waitcnt lgkmcnt(1)
    v_mfma_f32_32x32x16_bf16 v[128:143], v[184:187], v[40:43], v[128:143]
    v_max3_f32 v5, v112, v113, v114
    v_max3_f32 v5, v5, v115, v116
    v_max3_f32 v5, v5, v117, v118
    v_max3_f32 v5, v5, v119, v120
    s_waitcnt lgkmcnt(0)
    v_mfma_f32_32x32x16_bf16 v[128:143], v[188:191], v[44:47], v[128:143]
    v_max3_f32 v5, v5, v121, v122
    v_max3_f32 v5, v5, v123, v124
    v_max3_f32 v5, v5, v125, v126
    s_nop 8
    v_max3_f32 v5, v5, v127, v128
    v_max3_f32 v5, v5, v129, v130
    v_max3_f32 v5, v5, v131, v132
    v_max3_f32 v5, v5, v133, v134
    v_max3_f32 v5, v5, v135, v136
    v_max3_f32 v5, v5, v137, v138
    v_max3_f32 v5, v5, v139, v140
    v_max3_f32 v5, v5, v141, v142
    v_max_f32 v5, v5, v143
    v_mov_b32 v6, v5
    s_nop 1
    v_permlane32_swap_b32 v5, v6
    v_max_f32 v2, v5, v6
    v_sub_f32 v112, v112, v2
    v_sub_f32 v113, v113, v2
    v_exp_f32 v112, v112
    v_sub_f32 v114, v114, v2
    v_exp_f32 v113, v113
    v_sub_f32 v115, v115, v2
    v_exp_f32 v114, v114
    v_mov_b32 v9, v112
    v_sub_f32 v116, v116, v2
    v_exp_f32 v115, v115
    v_mov_b32 v10, v113
    v_sub_f32 v117, v117, v2
    v_exp_f32 v116, v116
    v_add_f32 v9, v9, v114
    v_sub_f32 v118, v118, v2
    v_exp_f32 v117, v117
    v_add_f32 v10, v10, v115
    v_sub_f32 v119, v119, v2
    v_exp_f32 v118, v118
    v_add_f32 v9, v9, v116
    v_sub_f32 v120, v120, v2
    v_exp_f32 v119, v119
    v_add_f32 v10, v10, v117
    v_sub_f32 v121, v121, v2
    v_exp_f32 v120, v120
    v_add_f32 v9, v9, v118
    v_sub_f32 v122, v122, v2
    v_exp_f32 v121, v121
    v_add_f32 v10, v10, v119
    v_sub_f32 v123, v123, v2
    v_exp_f32 v122, v122
    v_add_f32 v9, v9, v120
    v_sub_f32 v124, v124, v2
    v_exp_f32 v123, v123
    v_add_f32 v10, v10, v121
    v_sub_f32 v125, v125, v2
    v_exp_f32 v124, v124
    v_add_f32 v9, v9, v122
    v_sub_f32 v126, v126, v2
    v_exp_f32 v125, v125
    v_add_f32 v10, v10, v123
    v_sub_f32 v127, v127, v2
    v_exp_f32 v126, v126
    v_add_f32 v9, v9, v124
    v_sub_f32 v128, v128, v2
    v_exp_f32 v127, v127
    v_add_f32 v10, v10, v125
    v_sub_f32 v129, v129, v2
    v_exp_f32 v128, v128
    v_add_f32 v9, v9, v126
    v_sub_f32 v130, v130, v2
    v_exp_f32 v129, v129
    v_add_f32 v10, v10, v127
    v_sub_f32 v131, v131, v2
    v_exp_f32 v130, v130
    v_add_f32 v9, v9, v128
    v_sub_f32 v132, v132, v2
    v_exp_f32 v131, v131
    v_add_f32 v10, v10, v129
    v_sub_f32 v133, v133, v2
    v_exp_f32 v132, v132
    v_add_f32 v9, v9, v130
    v_sub_f32 v134, v134, v2
    v_exp_f32 v133, v133
    v_add_f32 v10, v10, v131
    v_sub_f32 v135, v135, v2
    v_exp_f32 v134, v134
    v_add_f32 v9, v9, v132
    v_sub_f32 v136, v136, v2
    v_exp_f32 v135, v135
    v_add_f32 v10, v10, v133
    v_sub_f32 v137, v137, v2
    v_exp_f32 v136, v136
    v_add_f32 v9, v9, v134
    v_sub_f32 v138, v138, v2
    v_exp_f32 v137, v137
    v_add_f32 v10, v10, v135
    v_sub_f32 v139, v139, v2
    v_exp_f32 v138, v138
    v_add_f32 v9, v9, v136
    v_sub_f32 v140, v140, v2
    v_exp_f32 v139, v139
    v_add_f32 v10, v10, v137
    v_sub_f32 v141, v141, v2
    v_exp_f32 v140, v140
    v_add_f32 v9, v9, v138
    v_sub_f32 v142, v142, v2
    v_exp_f32 v141, v141
    v_add_f32 v10, v10, v139
    v_sub_f32 v143, v143, v2
    v_exp_f32 v142, v142
    v_add_f32 v9, v9, v140
    v_exp_f32 v143, v143
    v_add_f32 v10, v10, v141
    v_add_f32 v9, v9, v142
    v_add_f32 v10, v10, v143
    v_sub_f32 v224, 0, v2
    v_sub_f32 v225, 0, v2
    v_sub_f32 v226, 0, v2
    v_sub_f32 v227, 0, v2
    v_sub_f32 v228, 0, v2
    v_sub_f32 v229, 0, v2
    v_sub_f32 v230, 0, v2
    v_sub_f32 v231, 0, v2
    v_sub_f32 v232, 0, v2
    v_sub_f32 v233, 0, v2
    v_sub_f32 v234, 0, v2
    v_sub_f32 v235, 0, v2
    v_sub_f32 v236, 0, v2
    v_sub_f32 v237, 0, v2
    v_sub_f32 v238, 0, v2
    v_sub_f32 v239, 0, v2
    v_add_f32 v9, v9, v10
L_main:
    v_add_u32 v14, 1, v14
    ds_write_b32 v13, v14
    ds_read_b32 v254, v12
    v_xor_b32 v240, s65, v240
    v_xor_b32 v241, s65, v241
    v_xor_b32 v242, s65, v242
    v_xor_b32 v243, s65, v243
    v_xor_b32 v244, s65, v244
    v_xor_b32 v245, s65, v245
    v_xor_b32 v246, s65, v246
    v_xor_b32 v247, s65, v247
    ds_read_b128 v[160:163], v240 offset:0
    ds_read_b128 v[164:167], v241 offset:0
    ds_read_b128 v[168:171], v242 offset:0
    ds_read_b128 v[172:175], v243 offset:0
    ds_read_b128 v[176:179], v244 offset:0
    ds_read_b128 v[180:183], v245 offset:0
    ds_read_b128 v[184:187], v246 offset:0
    ds_read_b128 v[188:191], v247 offset:0
    v_cvt_pk_bf16_f32 v144, v112, v113
    v_cvt_pk_bf16_f32 v145, v114, v115
    v_cvt_pk_bf16_f32 v146, v116, v117
    v_cvt_pk_bf16_f32 v147, v118, v119
    v_cvt_pk_bf16_f32 v148, v120, v121
    v_cvt_pk_bf16_f32 v149, v122, v123
    v_cvt_pk_bf16_f32 v150, v124, v125
    v_cvt_pk_bf16_f32 v151, v126, v127
    v_cvt_pk_bf16_f32 v152, v128, v129
    v_cvt_pk_bf16_f32 v153, v130, v131
    v_cvt_pk_bf16_f32 v154, v132, v133
    v_cvt_pk_bf16_f32 v155, v134, v135
    v_cvt_pk_bf16_f32 v156, v136, v137
    v_cvt_pk_bf16_f32 v157, v138, v139
    v_cvt_pk_bf16_f32 v158, v140, v141
    v_cvt_pk_bf16_f32 v159, v142, v143
    v_add_f32 v3, v3, v9
    s_mov_b32 s65, s66
    s_xor_b32 s66, s66, 0x10000
    s_add_u32 s71, s71, 2
    s_add_u32 s64, s64, 1
.p2align 3
L_loopA:
    s_cmp_le_u32 s64, 1
    s_cbranch_scc1 L_special
L_special_ret:
    s_waitcnt lgkmcnt(8)
    v_readfirstlane_b32 s73, v254
    s_nop 0
    s_cmp_ge_u32 s73, s71
    s_cbranch_scc1 L_goA
    s_call_b64 s[94:95], L_wland
L_goA:
    s_waitcnt lgkmcnt(7)
    v_mfma_f32_32x32x16_bf16 v[112:127], v[160:163], v[16:19], v[224:239]
    ds_read_b128 v[160:163], v240 offset:8192
    s_waitcnt lgkmcnt(7)
    v_mfma_f32_32x32x16_bf16 v[112:127], v[164:167], v[20:23], v[112:127]
    ds_read_b128 v[164:167], v241 offset:8192
    s_waitcnt lgkmcnt(7)
    v_mfma_f32_32x32x16_bf16 v[112:127], v[168:171], v[24:27], v[112:127]
    ds_read_b128 v[168:171], v242 offset:8192
    s_waitcnt lgkmcnt(7)
    v_mfma_f32_32x32x16_bf16 v[112:127], v[172:175], v[28:31], v[112:127]
    ds_read_b128 v[172:175], v243 offset:8192
    s_waitcnt lgkmcnt(7)
    v_mfma_f32_32x32x16_bf16 v[112:127], v[176:179], v[32:35], v[112:127]
    ds_read_b128 v[176:179], v244 offset:8192
    s_waitcnt lgkmcnt(7)
    v_mfma_f32_32x32x16_bf16 v[112:127], v[180:183], v[36:39], v[112:127]
    ds_read_b128 v[180:183], v245 offset:8192
    s_waitcnt lgkmcnt(7)
    v_mfma_f32_32x32x16_bf16 v[112:127], v[184:187], v[40:43], v[112:127]
    ds_read_b128 v[184:187], v246 offset:8192
    s_waitcnt lgkmcnt(7)
    v_mfma_f32_32x32x16_bf16 v[112:127], v[188:191], v[44:47], v[112:127]
    ds_read_b128 v[188:191], v247 offset:8192
    s_waitcnt lgkmcnt(7)
    v_mfma_f32_32x32x16_bf16 v[128:143], v[160:163], v[16:19], v[224:239]
    ds_read_b64_tr_b16 v[192:193], v248 offset:0
    ds_read_b64_tr_b16 v[194:195], v248 offset:2048
    s_waitcnt lgkmcnt(8)
    v_mfma_f32_32x32x16_bf16 v[128:143], v[164:167], v[20:23], v[128:143]
    ds_read_b64_tr_b16 v[196:197], v249 offset:0
    ds_read_b64_tr_b16 v[198:199], v249 offset:2048
    s_waitcnt lgkmcnt(9)
    v_mfma_f32_32x32x16_bf16 v[128:143], v[168:171], v[24:27], v[128:143]
    ds_read_b64_tr_b16 v[200:201], v250 offset:0
    ds_read_b64_tr_b16 v[202:203], v250 offset:2048
    s_waitcnt lgkmcnt(10)
    v_mfma_f32_32x32x16_bf16 v[128:143], v[172:175], v[28:31], v[128:143]
    ds_read_b64_tr_b16 v[204:205], v251 offset:0
    ds_read_b64_tr_b16 v[206:207], v251 offset:2048
    v_exp_f32 v112, v112
    v_exp_f32 v113, v113
    v_exp_f32 v114, v114
    v_mov_b32 v9, v112
    s_waitcnt lgkmcnt(11)
    v_mfma_f32_32x32x16_bf16 v[128:143], v[176:179], v[32:35], v[128:143]
    ds_read_b64_tr_b16 v[208:209], v248 offset:4096
    ds_read_b64_tr_b16 v[210:211], v248 offset:6144
    v_exp_f32 v115, v115
    v_mov_b32 v10, v113
    v_exp_f32 v116, v116
    v_add_f32 v9, v9, v114
    s_waitcnt lgkmcnt(12)
    v_mfma_f32_32x32x16_bf16 v[128:143], v[180:183], v[36:39], v[128:143]
    ds_read_b64_tr_b16 v[212:213], v249 offset:4096
    ds_read_b64_tr_b16 v[214:215], v249 offset:6144
    v_exp_f32 v117, v117
    v_add_f32 v10, v10, v115
    v_exp_f32 v118, v118
    v_add_f32 v9, v9, v116
    s_waitcnt lgkmcnt(13)
    v_mfma_f32_32x32x16_bf16 v[128:143], v[184:187], v[40:43], v[128:143]
    v_exp_f32 v119, v119
    v_add_f32 v10, v10, v117
    v_exp_f32 v120, v120
    v_add_f32 v9, v9, v118
    s_waitcnt lgkmcnt(12)
    v_mfma_f32_32x32x16_bf16 v[128:143], v[188:191], v[44:47], v[128:143]
    v_exp_f32 v121, v121
    v_add_f32 v10, v10, v119
    v_exp_f32 v122, v122
    v_add_f32 v9, v9, v120
    s_waitcnt lgkmcnt(10)
    v_mfma_f32_32x32x16_bf16 v[48:63], v[192:195], v[144:147], v[48:63]
    ds_read_b64_tr_b16 v[216:217], v250 offset:4096
    ds_read_b64_tr_b16 v[218:219], v250 offset:6144
    v_exp_f32 v123, v123
    v_add_f32 v10, v10, v121
    v_exp_f32 v124, v124
    s_waitcnt lgkmcnt(10)
    v_mfma_f32_32x32x16_bf16 v[64:79], v[196:199], v[144:147], v[64:79]
    ds_read_b64_tr_b16 v[220:221], v251 offset:4096
    ds_read_b64_tr_b16 v[222:223], v251 offset:6144
    v_add_f32 v9, v9, v122
    v_exp_f32 v125, v125
    v_add_f32 v10, v10, v123
    s_waitcnt lgkmcnt(10)
    v_mfma_f32_32x32x16_bf16 v[80:95], v[200:203], v[144:147], v[80:95]
    ds_read_b64_tr_b16 v[192:193], v248 offset:8192
    ds_read_b64_tr_b16 v[194:195], v248 offset:10240
    v_exp_f32 v126, v126
    v_add_f32 v9, v9, v124
    v_exp_f32 v127, v127
    s_waitcnt lgkmcnt(10)
    v_mfma_f32_32x32x16_bf16 v[96:111], v[204:207], v[144:147], v[96:111]
    ds_read_b64_tr_b16 v[196:197], v249 offset:8192
    ds_read_b64_tr_b16 v[198:199], v249 offset:10240
    v_add_f32 v10, v10, v125
    v_add_f32 v9, v9, v126
    v_add_f32 v10, v10, v127
    s_waitcnt lgkmcnt(10)
    v_mfma_f32_32x32x16_bf16 v[48:63], v[208:211], v[148:151], v[48:63]
    ds_read_b64_tr_b16 v[200:201], v250 offset:8192
    ds_read_b64_tr_b16 v[202:203], v250 offset:10240
    v_exp_f32 v128, v128
    v_exp_f32 v129, v129
    v_exp_f32 v130, v130
    s_waitcnt lgkmcnt(10)
    v_mfma_f32_32x32x16_bf16 v[64:79], v[212:215], v[148:151], v[64:79]
    ds_read_b64_tr_b16 v[204:205], v251 offset:8192
    ds_read_b64_tr_b16 v[206:207], v251 offset:10240
    v_add_f32 v9, v9, v128
    v_exp_f32 v131, v131
    v_add_f32 v10, v10, v129
    s_waitcnt lgkmcnt(10)
    v_mfma_f32_32x32x16_bf16 v[80:95], v[216:219], v[148:151], v[80:95]
    ds_read_b64_tr_b16 v[208:209], v248 offset:12288
    ds_read_b64_tr_b16 v[210:211], v248 offset:14336
    v_exp_f32 v132, v132
    v_add_f32 v9, v9, v130
    v_exp_f32 v133, v133
    s_waitcnt lgkmcnt(10)
    v_mfma_f32_32x32x16_bf16 v[96:111], v[220:223], v[148:151], v[96:111]
    ds_read_b64_tr_b16 v[212:213], v249 offset:12288
    ds_read_b64_tr_b16 v[214:215], v249 offset:14336
    v_add_f32 v10, v10, v131
    v_exp_f32 v134, v134
    v_add_f32 v9, v9, v132
    s_waitcnt lgkmcnt(10)
    v_mfma_f32_32x32x16_bf16 v[48:63], v[192:195], v[152:155], v[48:63]
    ds_read_b64_tr_b16 v[216:217], v250 offset:12288
    ds_read_b64_tr_b16 v[218:219], v250 offset:14336
    v_exp_f32 v135, v135
    v_add_f32 v10, v10, v133
    v_exp_f32 v136, v136
    s_waitcnt lgkmcnt(10)
    v_mfma_f32_32x32x16_bf16 v[64:79], v[196:199], v[152:155], v[64:79]
    ds_read_b64_tr_b16 v[220:221], v251 offset:12288
    ds_read_b64_tr_b16 v[222:223], v251 offset:14336
    v_add_f32 v9, v9, v134
    v_exp_f32 v137, v137
    v_add_f32 v10, v10, v135
    s_waitcnt lgkmcnt(10)
    v_mfma_f32_32x32x16_bf16 v[80:95], v[200:203], v[152:155], v[80:95]
    v_xor_b32 v248, s66, v248
    v_xor_b32 v249, s66, v249
    v_xor_b32 v250, s66, v250
    v_xor_b32 v251, s66, v251
    v_exp_f32 v138, v138
    v_add_f32 v9, v9, v136
    v_exp_f32 v139, v139
    v_add_f32 v10, v10, v137
    v_exp_f32 v140, v140
    s_waitcnt lgkmcnt(8)
    v_mfma_f32_32x32x16_bf16 v[96:111], v[204:207], v[152:155], v[96:111]
    v_add_f32 v9, v9, v138
    v_exp_f32 v141, v141
    v_add_f32 v10, v10, v139
    v_exp_f32 v142, v142
    v_add_f32 v9, v9, v140
    s_waitcnt lgkmcnt(6)
    v_mfma_f32_32x32x16_bf16 v[48:63], v[208:211], v[156:159], v[48:63]
    v_exp_f32 v143, v143
    v_add_f32 v10, v10, v141
    v_add_f32 v9, v9, v142
    v_add_f32 v10, v10, v143
    v_add_f32 v9, v9, v10
    s_waitcnt lgkmcnt(4)
    v_mfma_f32_32x32x16_bf16 v[64:79], v[212:215], v[156:159], v[64:79]
    v_cmp_nge_f32 vcc, s100, v9
    s_waitcnt lgkmcnt(2)
    v_mfma_f32_32x32x16_bf16 v[80:95], v[216:219], v[156:159], v[80:95]
    s_waitcnt lgkmcnt(0)
    v_mfma_f32_32x32x16_bf16 v[96:111], v[220:223], v[156:159], v[96:111]
    s_cbranch_vccz L_joinA
    s_call_b64 s[94:95], L_slow
L_joinA:
    v_add_u32 v14, 1, v14
    ds_write_b32 v13, v14
    ds_read_b32 v254, v12
    v_xor_b32 v240, s65, v240
    v_xor_b32 v241, s65, v241
    v_xor_b32 v242, s65, v242
    v_xor_b32 v243, s65, v243
    v_xor_b32 v244, s65, v244
    v_xor_b32 v245, s65, v245
    v_xor_b32 v246, s65, v246
    v_xor_b32 v247, s65, v247
    ds_read_b128 v[160:163], v240 offset:0
    ds_read_b128 v[164:167], v241 offset:0
    ds_read_b128 v[168:171], v242 offset:0
    ds_read_b128 v[172:175], v243 offset:0
    ds_read_b128 v[176:179], v244 offset:0
    ds_read_b128 v[180:183], v245 offset:0
    ds_read_b128 v[184:187], v246 offset:0
    ds_read_b128 v[188:191], v247 offset:0
    v_cvt_pk_bf16_f32 v144, v112, v113
    v_cvt_pk_bf16_f32 v145, v114, v115
    v_cvt_pk_bf16_f32 v146, v116, v117
    v_cvt_pk_bf16_f32 v147, v118, v119
    v_cvt_pk_bf16_f32 v148, v120, v121
    v_cvt_pk_bf16_f32 v149, v122, v123
    v_cvt_pk_bf16_f32 v150, v124, v125
    v_cvt_pk_bf16_f32 v151, v126, v127
    v_cvt_pk_bf16_f32 v152, v128, v129
    v_cvt_pk_bf16_f32 v153, v130, v131
    v_cvt_pk_bf16_f32 v154, v132, v133
    v_cvt_pk_bf16_f32 v155, v134, v135
    v_cvt_pk_bf16_f32 v156, v136, v137
    v_cvt_pk_bf16_f32 v157, v138, v139
    v_cvt_pk_bf16_f32 v158, v140, v141
    v_cvt_pk_bf16_f32 v159, v142, v143
    v_add_f32 v3, v3, v9
    s_mov_b32 s65, s66
    s_xor_b32 s66, s66, 0x10000
    s_add_u32 s71, s71, 2
    s_add_u32 s64, s64, 1
    s_cmp_lg_u32 s64, s77
    s_cbranch_scc1 L_loopA
    s_waitcnt lgkmcnt(8)
    v_readfirstlane_b32 s73, v254
    s_nop 0
    s_cmp_ge_u32 s73, s71
    s_cbranch_scc1 L_goW0
    s_call_b64 s[94:95], L_wland
L_goW0:
    s_waitcnt lgkmcnt(7)
    v_mfma_f32_32x32x16_bf16 v[112:127], v[160:163], v[16:19], v[224:239]
    ds_read_b128 v[160:163], v240 offset:8192
    buffer_load_dwordx4 a[0:3], v1, s[36:39], s70 offen offset:0 sc1
    s_waitcnt lgkmcnt(7)
    v_mfma_f32_32x32x16_bf16 v[112:127], v[164:167], v[20:23], v[112:127]
    ds_read_b128 v[164:167], v241 offset:8192
    buffer_load_dwordx4 a[4:7], v1, s[36:39], s70 offen offset:1024 sc1
    s_waitcnt lgkmcnt(7)
    v_mfma_f32_32x32x16_bf16 v[112:127], v[168:171], v[24:27], v[112:127]
    ds_read_b128 v[168:171], v242 offset:8192
    buffer_load_dwordx4 a[8:11], v1, s[36:39], s70 offen offset:2048 sc1
    s_waitcnt lgkmcnt(7)
    v_mfma_f32_32x32x16_bf16 v[112:127], v[172:175], v[28:31], v[112:127]
    ds_read_b128 v[172:175], v243 offset:8192
    buffer_load_dwordx4 a[12:15], v1, s[36:39], s70 offen offset:3072 sc1
    s_add_u32 s70, s70, s74
    s_waitcnt lgkmcnt(7)
    v_mfma_f32_32x32x16_bf16 v[112:127], v[176:179], v[32:35], v[112:127]
    ds_read_b128 v[176:179], v244 offset:8192
    buffer_load_dwordx4 a[16:19], v1, s[36:39], s70 offen offset:0 sc1
    s_waitcnt lgkmcnt(7)
    v_mfma_f32_32x32x16_bf16 v[112:127], v[180:183], v[36:39], v[112:127]
    ds_read_b128 v[180:183], v245 offset:8192
    buffer_load_dwordx4 a[20:23], v1, s[36:39], s70 offen offset:1024 sc1
    s_waitcnt lgkmcnt(7)
    v_mfma_f32_32x32x16_bf16 v[112:127], v[184:187], v[40:43], v[112:127]
    ds_read_b128 v[184:187], v246 offset:8192
    buffer_load_dwordx4 a[24:27], v1, s[36:39], s70 offen offset:2048 sc1
    s_waitcnt lgkmcnt(7)
    v_mfma_f32_32x32x16_bf16 v[112:127], v[188:191], v[44:47], v[112:127]
    ds_read_b128 v[188:191], v247 offset:8192
    buffer_load_dwordx4 a[28:31], v1, s[36:39], s70 offen offset:3072 sc1
    s_add_u32 s70, s70, s74
    s_waitcnt lgkmcnt(7)
    v_mfma_f32_32x32x16_bf16 v[128:143], v[160:163], v[16:19], v[224:239]
    ds_read_b64_tr_b16 v[192:193], v248 offset:0
    ds_read_b64_tr_b16 v[194:195], v248 offset:2048
    buffer_load_dwordx4 a[32:35], v1, s[36:39], s70 offen offset:0 sc1
    s_waitcnt lgkmcnt(8)
    v_mfma_f32_32x32x16_bf16 v[128:143], v[164:167], v[20:23], v[128:143]
    ds_read_b64_tr_b16 v[196:197], v249 offset:0
    ds_read_b64_tr_b16 v[198:199], v249 offset:2048
    buffer_load_dwordx4 a[36:39], v1, s[36:39], s70 offen offset:1024 sc1
    s_waitcnt lgkmcnt(9)
    v_mfma_f32_32x32x16_bf16 v[128:143], v[168:171], v[24:27], v[128:143]
    ds_read_b64_tr_b16 v[200:201], v250 offset:0
    ds_read_b64_tr_b16 v[202:203], v250 offset:2048
    buffer_load_dwordx4 a[40:43], v1, s[36:39], s70 offen offset:2048 sc1
    s_waitcnt lgkmcnt(10)
    v_mfma_f32_32x32x16_bf16 v[128:143], v[172:175], v[28:31], v[128:143]
    ds_read_b64_tr_b16 v[204:205], v251 offset:0
    ds_read_b64_tr_b16 v[206:207], v251 offset:2048
    v_exp_f32 v112, v112
    v_exp_f32 v113, v113
    v_exp_f32 v114, v114
    v_mov_b32 v9, v112
    buffer_load_dwordx4 a[44:47], v1, s[36:39], s70 offen offset:3072 sc1
    s_add_u32 s70, s70, s74
    s_waitcnt lgkmcnt(11)
    v_mfma_f32_32x32x16_bf16 v[128:143], v[176:179], v[32:35], v[128:143]
    ds_read_b64_tr_b16 v[208:209], v248 offset:4096
    ds_read_b64_tr_b16 v[210:211], v248 offset:6144
    v_exp_f32 v115, v115
    v_mov_b32 v10, v113
    v_exp_f32 v116, v116
    v_add_f32 v9, v9, v114
    buffer_load_dwordx4 a[48:51], v1, s[36:39], s70 offen offset:0 sc1
    s_waitcnt lgkmcnt(12)
    v_mfma_f32_32x32x16_bf16 v[128:143], v[180:183], v[36:39], v[128:143]
    ds_read_b64_tr_b16 v[212:213], v249 offset:4096
    ds_read_b64_tr_b16 v[214:215], v249 offset:6144
    v_exp_f32 v117, v117
    v_add_f32 v10, v10, v115
    v_exp_f32 v118, v118
    v_add_f32 v9, v9, v116
    buffer_load_dwordx4 a[52:55], v1, s[36:39], s70 offen offset:1024 sc1
    s_waitcnt lgkmcnt(13)
    v_mfma_f32_32x32x16_bf16 v[128:143], v[184:187], v[40:43], v[128:143]
    v_exp_f32 v119, v119
    v_add_f32 v10, v10, v117
    v_exp_f32 v120, v120
    v_add_f32 v9, v9, v118
    buffer_load_dwordx4 a[56:59], v1, s[36:39], s70 offen offset:2048 sc1
    s_waitcnt lgkmcnt(12)
    v_mfma_f32_32x32x16_bf16 v[128:143], v[188:191], v[44:47], v[128:143]
    v_exp_f32 v121, v121
    v_add_f32 v10, v10, v119
    v_exp_f32 v122, v122
    v_add_f32 v9, v9, v120
    buffer_load_dwordx4 a[60:63], v1, s[36:39], s70 offen offset:3072 sc1
    s_add_u32 s70, s70, s74
    s_waitcnt lgkmcnt(10)
    v_mfma_f32_32x32x16_bf16 v[48:63], v[192:195], v[144:147], v[48:63]
    ds_read_b64_tr_b16 v[216:217], v250 offset:4096
    ds_read_b64_tr_b16 v[218:219], v250 offset:6144
    v_exp_f32 v123, v123
    v_add_f32 v10, v10, v121
    v_exp_f32 v124, v124
    buffer_load_dwordx4 a[64:67], v1, s[36:39], s70 offen offset:0 sc1
    s_waitcnt lgkmcnt(10)
    v_mfma_f32_32x32x16_bf16 v[64:79], v[196:199], v[144:147], v[64:79]
    ds_read_b64_tr_b16 v[220:221], v251 offset:4096
    ds_read_b64_tr_b16 v[222:223], v251 offset:6144
    v_add_f32 v9, v9, v122
    v_exp_f32 v125, v125
    v_add_f32 v10, v10, v123
    buffer_load_dwordx4 a[68:71], v1, s[36:39], s70 offen offset:1024 sc1
    s_waitcnt lgkmcnt(10)
    v_mfma_f32_32x32x16_bf16 v[80:95], v[200:203], v[144:147], v[80:95]
    ds_read_b64_tr_b16 v[192:193], v248 offset:8192
    ds_read_b64_tr_b16 v[194:195], v248 offset:10240
    v_exp_f32 v126, v126
    v_add_f32 v9, v9, v124
    v_exp_f32 v127, v127
    buffer_load_dwordx4 a[72:75], v1, s[36:39], s70 offen offset:2048 sc1
    s_waitcnt lgkmcnt(10)
    v_mfma_f32_32x32x16_bf16 v[96:111], v[204:207], v[144:147], v[96:111]
    ds_read_b64_tr_b16 v[196:197], v249 offset:8192
    ds_read_b64_tr_b16 v[198:199], v249 offset:10240
    v_add_f32 v10, v10, v125
    v_add_f32 v9, v9, v126
    v_add_f32 v10, v10, v127
    buffer_load_dwordx4 a[76:79], v1, s[36:39], s70 offen offset:3072 sc1
    s_add_u32 s70, s70, s74
    s_waitcnt lgkmcnt(10)
    v_mfma_f32_32x32x16_bf16 v[48:63], v[208:211], v[148:151], v[48:63]
    ds_read_b64_tr_b16 v[200:201], v250 offset:8192
    ds_read_b64_tr_b16 v[202:203], v250 offset:10240
    v_exp_f32 v128, v128
    v_exp_f32 v129, v129
    v_exp_f32 v130, v130
    buffer_load_dwordx4 a[80:83], v1, s[36:39], s70 offen offset:0 sc1
    s_waitcnt lgkmcnt(10)
    v_mfma_f32_32x32x16_bf16 v[64:79], v[212:215], v[148:151], v[64:79]
    ds_read_b64_tr_b16 v[204:205], v251 offset:8192
    ds_read_b64_tr_b16 v[206:207], v251 offset:10240
    v_add_f32 v9, v9, v128
    v_exp_f32 v131, v131
    v_add_f32 v10, v10, v129
    buffer_load_dwordx4 a[84:87], v1, s[36:39], s70 offen offset:1024 sc1
    s_waitcnt lgkmcnt(10)
    v_mfma_f32_32x32x16_bf16 v[80:95], v[216:219], v[148:151], v[80:95]
    ds_read_b64_tr_b16 v[208:209], v248 offset:12288
    ds_read_b64_tr_b16 v[210:211], v248 offset:14336
    v_exp_f32 v132, v132
    v_add_f32 v9, v9, v130
    v_exp_f32 v133, v133
    buffer_load_dwordx4 a[88:91], v1, s[36:39], s70 offen offset:2048 sc1
    s_waitcnt lgkmcnt(10)
    v_mfma_f32_32x32x16_bf16 v[96:111], v[220:223], v[148:151], v[96:111]
    ds_read_b64_tr_b16 v[212:213], v249 offset:12288
    ds_read_b64_tr_b16 v[214:215], v249 offset:14336
    v_add_f32 v10, v10, v131
    v_exp_f32 v134, v134
    v_add_f32 v9, v9, v132
    buffer_load_dwordx4 a[92:95], v1, s[36:39], s70 offen offset:3072 sc1
    s_add_u32 s70, s70, s74
    s_waitcnt lgkmcnt(10)
    v_mfma_f32_32x32x16_bf16 v[48:63], v[192:195], v[152:155], v[48:63]
    ds_read_b64_tr_b16 v[216:217], v250 offset:12288
    ds_read_b64_tr_b16 v[218:219], v250 offset:14336
    v_exp_f32 v135, v135
    v_add_f32 v10, v10, v133
    v_exp_f32 v136, v136
    buffer_load_dwordx4 a[96:99], v1, s[36:39], s70 offen offset:0 sc1
    s_waitcnt lgkmcnt(10)
    v_mfma_f32_32x32x16_bf16 v[64:79], v[196:199], v[152:155], v[64:79]
    ds_read_b64_tr_b16 v[220:221], v251 offset:12288
    ds_read_b64_tr_b16 v[222:223], v251 offset:14336
    v_add_f32 v9, v9, v134
    v_exp_f32 v137, v137
    v_add_f32 v10, v10, v135
    buffer_load_dwordx4 a[100:103], v1, s[36:39], s70 offen offset:1024 sc1
    s_waitcnt lgkmcnt(10)
    v_mfma_f32_32x32x16_bf16 v[80:95], v[200:203], v[152:155], v[80:95]
    v_xor_b32 v248, s66, v248
    v_xor_b32 v249, s66, v249
    v_xor_b32 v250, s66, v250
    v_xor_b32 v251, s66, v251
    v_exp_f32 v138, v138
    v_add_f32 v9, v9, v136
    v_exp_f32 v139, v139
    v_add_f32 v10, v10, v137
    v_exp_f32 v140, v140
    buffer_load_dwordx4 a[104:107], v1, s[36:39], s70 offen offset:2048 sc1
    s_waitcnt lgkmcnt(8)
    v_mfma_f32_32x32x16_bf16 v[96:111], v[204:207], v[152:155], v[96:111]
    v_add_f32 v9, v9, v138
    v_exp_f32 v141, v141
    v_add_f32 v10, v10, v139
    v_exp_f32 v142, v142
    v_add_f32 v9, v9, v140
    buffer_load_dwordx4 a[108:111], v1, s[36:39], s70 offen offset:3072 sc1
    s_add_u32 s70, s70, s74
    s_waitcnt lgkmcnt(6)
    v_mfma_f32_32x32x16_bf16 v[48:63], v[208:211], v[156:159], v[48:63]
    v_exp_f32 v143, v143
    v_add_f32 v10, v10, v141
    v_add_f32 v9, v9, v142
    v_add_f32 v10, v10, v143
    v_add_f32 v9, v9, v10
    buffer_load_dwordx4 a[112:115], v1, s[36:39], s70 offen offset:0 sc1
    s_waitcnt lgkmcnt(4)
    v_mfma_f32_32x32x16_bf16 v[64:79], v[212:215], v[156:159], v[64:79]
    v_cmp_nge_f32 vcc, s100, v9
    buffer_load_dwordx4 a[116:119], v1, s[36:39], s70 offen offset:1024 sc1
    s_waitcnt lgkmcnt(2)
    v_mfma_f32_32x32x16_bf16 v[80:95], v[216:219], v[156:159], v[80:95]
    buffer_load_dwordx4 a[120:123], v1, s[36:39], s70 offen offset:2048 sc1
    s_waitcnt lgkmcnt(0)
    v_mfma_f32_32x32x16_bf16 v[96:111], v[220:223], v[156:159], v[96:111]
    buffer_load_dwordx4 a[124:127], v1, s[36:39], s70 offen offset:3072 sc1
    s_add_u32 s70, s70, s74
    s_cbranch_vccz L_joinW0
    s_call_b64 s[94:95], L_slow
L_joinW0:
    v_add_u32 v14, 1, v14
    ds_write_b32 v13, v14
    ds_read_b32 v254, v12
    v_xor_b32 v240, s65, v240
    v_xor_b32 v241, s65, v241
    v_xor_b32 v242, s65, v242
    v_xor_b32 v243, s65, v243
    v_xor_b32 v244, s65, v244
    v_xor_b32 v245, s65, v245
    v_xor_b32 v246, s65, v246
    v_xor_b32 v247, s65, v247
    ds_read_b128 v[160:163], v240 offset:0
    ds_read_b128 v[164:167], v241 offset:0
    ds_read_b128 v[168:171], v242 offset:0
    ds_read_b128 v[172:175], v243 offset:0
    ds_read_b128 v[176:179], v244 offset:0
    ds_read_b128 v[180:183], v245 offset:0
    ds_read_b128 v[184:187], v246 offset:0
    ds_read_b128 v[188:191], v247 offset:0
    v_cvt_pk_bf16_f32 v144, v112, v113
    v_cvt_pk_bf16_f32 v145, v114, v115
    v_cvt_pk_bf16_f32 v146, v116, v117
    v_cvt_pk_bf16_f32 v147, v118, v119
    v_cvt_pk_bf16_f32 v148, v120, v121
    v_cvt_pk_bf16_f32 v149, v122, v123
    v_cvt_pk_bf16_f32 v150, v124, v125
    v_cvt_pk_bf16_f32 v151, v126, v127
    v_cvt_pk_bf16_f32 v152, v128, v129
    v_cvt_pk_bf16_f32 v153, v130, v131
    v_cvt_pk_bf16_f32 v154, v132, v133
    v_cvt_pk_bf16_f32 v155, v134, v135
    v_cvt_pk_bf16_f32 v156, v136, v137
    v_cvt_pk_bf16_f32 v157, v138, v139
    v_cvt_pk_bf16_f32 v158, v140, v141
    v_cvt_pk_bf16_f32 v159, v142, v143
    v_add_f32 v3, v3, v9
    s_mov_b32 s65, s66
    s_xor_b32 s66, s66, 0x10000
    s_add_u32 s71, s71, 2
    s_add_u32 s64, s64, 1
    s_waitcnt lgkmcnt(8)
    v_readfirstlane_b32 s73, v254
    s_nop 0
    s_cmp_ge_u32 s73, s71
    s_cbranch_scc1 L_goW1
    s_call_b64 s[94:95], L_wland
L_goW1:
    s_waitcnt lgkmcnt(7)
    v_mfma_f32_32x32x16_bf16 v[112:127], v[160:163], v[16:19], v[224:239]
    ds_read_b128 v[160:163], v240 offset:8192
    buffer_load_dwordx4 a[128:131], v1, s[36:39], s70 offen offset:0 sc1
    s_waitcnt lgkmcnt(7)
    v_mfma_f32_32x32x16_bf16 v[112:127], v[164:167], v[20:23], v[112:127]
    ds_read_b128 v[164:167], v241 offset:8192
    buffer_load_dwordx4 a[132:135], v1, s[36:39], s70 offen offset:1024 sc1
    s_waitcnt lgkmcnt(7)
    v_mfma_f32_32x32x16_bf16 v[112:127], v[168:171], v[24:27], v[112:127]
    ds_read_b128 v[168:171], v242 offset:8192
    buffer_load_dwordx4 a[136:139], v1, s[36:39], s70 offen offset:2048 sc1
    s_waitcnt lgkmcnt(7)
    v_mfma_f32_32x32x16_bf16 v[112:127], v[172:175], v[28:31], v[112:127]
    ds_read_b128 v[172:175], v243 offset:8192
    buffer_load_dwordx4 a[140:143], v1, s[36:39], s70 offen offset:3072 sc1
    s_add_u32 s70, s70, s74
    s_waitcnt lgkmcnt(7)
    v_mfma_f32_32x32x16_bf16 v[112:127], v[176:179], v[32:35], v[112:127]
    ds_read_b128 v[176:179], v244 offset:8192
    buffer_load_dwordx4 a[144:147], v1, s[36:39], s70 offen offset:0 sc1
    s_waitcnt lgkmcnt(7)
    v_mfma_f32_32x32x16_bf16 v[112:127], v[180:183], v[36:39], v[112:127]
    ds_read_b128 v[180:183], v245 offset:8192
    buffer_load_dwordx4 a[148:151], v1, s[36:39], s70 offen offset:1024 sc1
    s_waitcnt lgkmcnt(7)
    v_mfma_f32_32x32x16_bf16 v[112:127], v[184:187], v[40:43], v[112:127]
    ds_read_b128 v[184:187], v246 offset:8192
    buffer_load_dwordx4 a[152:155], v1, s[36:39], s70 offen offset:2048 sc1
    s_waitcnt lgkmcnt(7)
    v_mfma_f32_32x32x16_bf16 v[112:127], v[188:191], v[44:47], v[112:127]
    ds_read_b128 v[188:191], v247 offset:8192
    buffer_load_dwordx4 a[156:159], v1, s[36:39], s70 offen offset:3072 sc1
    s_add_u32 s70, s70, s74
    s_waitcnt lgkmcnt(7)
    v_mfma_f32_32x32x16_bf16 v[128:143], v[160:163], v[16:19], v[224:239]
    ds_read_b64_tr_b16 v[192:193], v248 offset:0
    ds_read_b64_tr_b16 v[194:195], v248 offset:2048
    buffer_load_dwordx4 a[160:163], v1, s[36:39], s70 offen offset:0 sc1
    s_waitcnt lgkmcnt(8)
    v_mfma_f32_32x32x16_bf16 v[128:143], v[164:167], v[20:23], v[128:143]
    ds_read_b64_tr_b16 v[196:197], v249 offset:0
    ds_read_b64_tr_b16 v[198:199], v249 offset:2048
    buffer_load_dwordx4 a[164:167], v1, s[36:39], s70 offen offset:1024 sc1
    s_waitcnt lgkmcnt(9)
    v_mfma_f32_32x32x16_bf16 v[128:143], v[168:171], v[24:27], v[128:143]
    ds_read_b64_tr_b16 v[200:201], v250 offset:0
    ds_read_b64_tr_b16 v[202:203], v250 offset:2048
    buffer_load_dwordx4 a[168:171], v1, s[36:39], s70 offen offset:2048 sc1
    s_waitcnt lgkmcnt(10)
    v_mfma_f32_32x32x16_bf16 v[128:143], v[172:175], v[28:31], v[128:143]
    ds_read_b64_tr_b16 v[204:205], v251 offset:0
    ds_read_b64_tr_b16 v[206:207], v251 offset:2048
    v_exp_f32 v112, v112
    v_exp_f32 v113, v113
    v_exp_f32 v114, v114
    v_mov_b32 v9, v112
    buffer_load_dwordx4 a[172:175], v1, s[36:39], s70 offen offset:3072 sc1
    s_add_u32 s70, s70, s74
    s_waitcnt lgkmcnt(11)
    v_mfma_f32_32x32x16_bf16 v[128:143], v[176:179], v[32:35], v[128:143]
    ds_read_b64_tr_b16 v[208:209], v248 offset:4096
    ds_read_b64_tr_b16 v[210:211], v248 offset:6144
    v_exp_f32 v115, v115
    v_mov_b32 v10, v113
    v_exp_f32 v116, v116
    v_add_f32 v9, v9, v114
    buffer_load_dwordx4 a[176:179], v1, s[36:39], s70 offen offset:0 sc1
    s_waitcnt lgkmcnt(12)
    v_mfma_f32_32x32x16_bf16 v[128:143], v[180:183], v[36:39], v[128:143]
    ds_read_b64_tr_b16 v[212:213], v249 offset:4096
    ds_read_b64_tr_b16 v[214:215], v249 offset:6144
    v_exp_f32 v117, v117
    v_add_f32 v10, v10, v115
    v_exp_f32 v118, v118
    v_add_f32 v9, v9, v116
    buffer_load_dwordx4 a[180:183], v1, s[36:39], s70 offen offset:1024 sc1
    s_waitcnt lgkmcnt(13)
    v_mfma_f32_32x32x16_bf16 v[128:143], v[184:187], v[40:43], v[128:143]
    v_exp_f32 v119, v119
    v_add_f32 v10, v10, v117
    v_exp_f32 v120, v120
    v_add_f32 v9, v9, v118
    buffer_load_dwordx4 a[184:187], v1, s[36:39], s70 offen offset:2048 sc1
    s_waitcnt lgkmcnt(12)
    v_mfma_f32_32x32x16_bf16 v[128:143], v[188:191], v[44:47], v[128:143]
    v_exp_f32 v121, v121
    v_add_f32 v10, v10, v119
    v_exp_f32 v122, v122
    v_add_f32 v9, v9, v120
    buffer_load_dwordx4 a[188:191], v1, s[36:39], s70 offen offset:3072 sc1
    s_add_u32 s70, s70, s74
    s_waitcnt lgkmcnt(10)
    v_mfma_f32_32x32x16_bf16 v[48:63], v[192:195], v[144:147], v[48:63]
    ds_read_b64_tr_b16 v[216:217], v250 offset:4096
    ds_read_b64_tr_b16 v[218:219], v250 offset:6144
    v_exp_f32 v123, v123
    v_add_f32 v10, v10, v121
    v_exp_f32 v124, v124
    buffer_load_dwordx4 a[192:195], v1, s[36:39], s70 offen offset:0 sc1
    s_waitcnt lgkmcnt(10)
    v_mfma_f32_32x32x16_bf16 v[64:79], v[196:199], v[144:147], v[64:79]
    ds_read_b64_tr_b16 v[220:221], v251 offset:4096
    ds_read_b64_tr_b16 v[222:223], v251 offset:6144
    v_add_f32 v9, v9, v122
    v_exp_f32 v125, v125
    v_add_f32 v10, v10, v123
    buffer_load_dwordx4 a[196:199], v1, s[36:39], s70 offen offset:1024 sc1
    s_waitcnt lgkmcnt(10)
    v_mfma_f32_32x32x16_bf16 v[80:95], v[200:203], v[144:147], v[80:95]
    ds_read_b64_tr_b16 v[192:193], v248 offset:8192
    ds_read_b64_tr_b16 v[194:195], v248 offset:10240
    v_exp_f32 v126, v126
    v_add_f32 v9, v9, v124
    v_exp_f32 v127, v127
    buffer_load_dwordx4 a[200:203], v1, s[36:39], s70 offen offset:2048 sc1
    s_waitcnt lgkmcnt(10)
    v_mfma_f32_32x32x16_bf16 v[96:111], v[204:207], v[144:147], v[96:111]
    ds_read_b64_tr_b16 v[196:197], v249 offset:8192
    ds_read_b64_tr_b16 v[198:199], v249 offset:10240
    v_add_f32 v10, v10, v125
    v_add_f32 v9, v9, v126
    v_add_f32 v10, v10, v127
    buffer_load_dwordx4 a[204:207], v1, s[36:39], s70 offen offset:3072 sc1
    s_add_u32 s70, s70, s74
    s_waitcnt lgkmcnt(10)
    v_mfma_f32_32x32x16_bf16 v[48:63], v[208:211], v[148:151], v[48:63]
    ds_read_b64_tr_b16 v[200:201], v250 offset:8192
    ds_read_b64_tr_b16 v[202:203], v250 offset:10240
    v_exp_f32 v128, v128
    v_exp_f32 v129, v129
    v_exp_f32 v130, v130
    buffer_load_dwordx4 a[208:211], v1, s[36:39], s70 offen offset:0 sc1
    s_waitcnt lgkmcnt(10)
    v_mfma_f32_32x32x16_bf16 v[64:79], v[212:215], v[148:151], v[64:79]
    ds_read_b64_tr_b16 v[204:205], v251 offset:8192
    ds_read_b64_tr_b16 v[206:207], v251 offset:10240
    v_add_f32 v9, v9, v128
    v_exp_f32 v131, v131
    v_add_f32 v10, v10, v129
    buffer_load_dwordx4 a[212:215], v1, s[36:39], s70 offen offset:1024 sc1
    s_waitcnt lgkmcnt(10)
    v_mfma_f32_32x32x16_bf16 v[80:95], v[216:219], v[148:151], v[80:95]
    ds_read_b64_tr_b16 v[208:209], v248 offset:12288
    ds_read_b64_tr_b16 v[210:211], v248 offset:14336
    v_exp_f32 v132, v132
    v_add_f32 v9, v9, v130
    v_exp_f32 v133, v133
    buffer_load_dwordx4 a[216:219], v1, s[36:39], s70 offen offset:2048 sc1
    s_waitcnt lgkmcnt(10)
    v_mfma_f32_32x32x16_bf16 v[96:111], v[220:223], v[148:151], v[96:111]
    ds_read_b64_tr_b16 v[212:213], v249 offset:12288
    ds_read_b64_tr_b16 v[214:215], v249 offset:14336
    v_add_f32 v10, v10, v131
    v_exp_f32 v134, v134
    v_add_f32 v9, v9, v132
    buffer_load_dwordx4 a[220:223], v1, s[36:39], s70 offen offset:3072 sc1
    s_add_u32 s70, s70, s74
    s_waitcnt lgkmcnt(10)
    v_mfma_f32_32x32x16_bf16 v[48:63], v[192:195], v[152:155], v[48:63]
    ds_read_b64_tr_b16 v[216:217], v250 offset:12288
    ds_read_b64_tr_b16 v[218:219], v250 offset:14336
    v_exp_f32 v135, v135
    v_add_f32 v10, v10, v133
    v_exp_f32 v136, v136
    buffer_load_dwordx4 a[224:227], v1, s[36:39], s70 offen offset:0 sc1
    s_waitcnt lgkmcnt(10)
    v_mfma_f32_32x32x16_bf16 v[64:79], v[196:199], v[152:155], v[64:79]
    ds_read_b64_tr_b16 v[220:221], v251 offset:12288
    ds_read_b64_tr_b16 v[222:223], v251 offset:14336
    v_add_f32 v9, v9, v134
    v_exp_f32 v137, v137
    v_add_f32 v10, v10, v135
    buffer_load_dwordx4 a[228:231], v1, s[36:39], s70 offen offset:1024 sc1
    s_waitcnt lgkmcnt(10)
    v_mfma_f32_32x32x16_bf16 v[80:95], v[200:203], v[152:155], v[80:95]
    v_xor_b32 v248, s66, v248
    v_xor_b32 v249, s66, v249
    v_xor_b32 v250, s66, v250
    v_xor_b32 v251, s66, v251
    v_exp_f32 v138, v138
    v_add_f32 v9, v9, v136
    v_exp_f32 v139, v139
    v_add_f32 v10, v10, v137
    v_exp_f32 v140, v140
    buffer_load_dwordx4 a[232:235], v1, s[36:39], s70 offen offset:2048 sc1
    s_waitcnt lgkmcnt(8)
    v_mfma_f32_32x32x16_bf16 v[96:111], v[204:207], v[152:155], v[96:111]
    v_add_f32 v9, v9, v138
    v_exp_f32 v141, v141
    v_add_f32 v10, v10, v139
    v_exp_f32 v142, v142
    v_add_f32 v9, v9, v140
    buffer_load_dwordx4 a[236:239], v1, s[36:39], s70 offen offset:3072 sc1
    s_add_u32 s70, s70, s74
    s_waitcnt lgkmcnt(6)
    v_mfma_f32_32x32x16_bf16 v[48:63], v[208:211], v[156:159], v[48:63]
    v_exp_f32 v143, v143
    v_add_f32 v10, v10, v141
    v_add_f32 v9, v9, v142
    v_add_f32 v10, v10, v143
    v_add_f32 v9, v9, v10
    buffer_load_dwordx4 a[240:243], v1, s[36:39], s70 offen offset:0 sc1
    s_waitcnt lgkmcnt(4)
    v_mfma_f32_32x32x16_bf16 v[64:79], v[212:215], v[156:159], v[64:79]
    v_cmp_nge_f32 vcc, s100, v9
    buffer_load_dwordx4 a[244:247], v1, s[36:39], s70 offen offset:1024 sc1
    s_waitcnt lgkmcnt(2)
    v_mfma_f32_32x32x16_bf16 v[80:95], v[216:219], v[156:159], v[80:95]
    buffer_load_dwordx4 a[248:251], v1, s[36:39], s70 offen offset:2048 sc1
    s_waitcnt lgkmcnt(0)
    v_mfma_f32_32x32x16_bf16 v[96:111], v[220:223], v[156:159], v[96:111]
    buffer_load_dwordx4 a[252:255], v1, s[36:39], s70 offen offset:3072 sc1
    s_add_u32 s70, s70, s74
    s_cbranch_vccz L_joinW1
    s_call_b64 s[94:95], L_slow
L_joinW1:
    v_add_u32 v14, 1, v14
    ds_write_b32 v13, v14
    ds_read_b32 v254, v12
    v_xor_b32 v240, s65, v240
    v_xor_b32 v241, s65, v241
    v_xor_b32 v242, s65, v242
    v_xor_b32 v243, s65, v243
    v_xor_b32 v244, s65, v244
    v_xor_b32 v245, s65, v245
    v_xor_b32 v246, s65, v246
    v_xor_b32 v247, s65, v247
    ds_read_b128 v[160:163], v240 offset:0
    ds_read_b128 v[164:167], v241 offset:0
    ds_read_b128 v[168:171], v242 offset:0
    ds_read_b128 v[172:175], v243 offset:0
    ds_read_b128 v[176:179], v244 offset:0
    ds_read_b128 v[180:183], v245 offset:0
    ds_read_b128 v[184:187], v246 offset:0
    ds_read_b128 v[188:191], v247 offset:0
    v_cvt_pk_bf16_f32 v144, v112, v113
    v_cvt_pk_bf16_f32 v145, v114, v115
    v_cvt_pk_bf16_f32 v146, v116, v117
    v_cvt_pk_bf16_f32 v147, v118, v119
    v_cvt_pk_bf16_f32 v148, v120, v121
    v_cvt_pk_bf16_f32 v149, v122, v123
    v_cvt_pk_bf16_f32 v150, v124, v125
    v_cvt_pk_bf16_f32 v151, v126, v127
    v_cvt_pk_bf16_f32 v152, v128, v129
    v_cvt_pk_bf16_f32 v153, v130, v131
    v_cvt_pk_bf16_f32 v154, v132, v133
    v_cvt_pk_bf16_f32 v155, v134, v135
    v_cvt_pk_bf16_f32 v156, v136, v137
    v_cvt_pk_bf16_f32 v157, v138, v139
    v_cvt_pk_bf16_f32 v158, v140, v141
    v_cvt_pk_bf16_f32 v159, v142, v143
    v_add_f32 v3, v3, v9
    s_mov_b32 s65, s66
    s_xor_b32 s66, s66, 0x10000
    s_add_u32 s71, s71, 2
    s_add_u32 s64, s64, 1
    s_cmp_eq_u32 s64, 15
    s_cbranch_scc1 L_tail
.p2align 3
L_loopB:
    s_waitcnt lgkmcnt(8)
    v_readfirstlane_b32 s73, v254
    s_nop 0
    s_cmp_ge_u32 s73, s71
    s_cbranch_scc1 L_goB
    s_call_b64 s[94:95], L_wland
L_goB:
    s_waitcnt lgkmcnt(7)
    v_mfma_f32_32x32x16_bf16 v[112:127], v[160:163], v[16:19], v[224:239]
    ds_read_b128 v[160:163], v240 offset:8192
    s_waitcnt lgkmcnt(7)
    v_mfma_f32_32x32x16_bf16 v[112:127], v[164:167], v[20:23], v[112:127]
    ds_read_b128 v[164:167], v241 offset:8192
    s_waitcnt lgkmcnt(7)
    v_mfma_f32_32x32x16_bf16 v[112:127], v[168:171], v[24:27], v[112:127]
    ds_read_b128 v[168:171], v242 offset:8192
    s_waitcnt lgkmcnt(7)
    v_mfma_f32_32x32x16_bf16 v[112:127], v[172:175], v[28:31], v[112:127]
    ds_read_b128 v[172:175], v243 offset:8192
    s_waitcnt lgkmcnt(7)
    v_mfma_f32_32x32x16_bf16 v[112:127], v[176:179], v[32:35], v[112:127]
    ds_read_b128 v[176:179], v244 offset:8192
    s_waitcnt lgkmcnt(7)
    v_mfma_f32_32x32x16_bf16 v[112:127], v[180:183], v[36:39], v[112:127]
    ds_read_b128 v[180:183], v245 offset:8192
    s_waitcnt lgkmcnt(7)
    v_mfma_f32_32x32x16_bf16 v[112:127], v[184:187], v[40:43], v[112:127]
    ds_read_b128 v[184:187], v246 offset:8192
    s_waitcnt lgkmcnt(7)
    v_mfma_f32_32x32x16_bf16 v[112:127], v[188:191], v[44:47], v[112:127]
    ds_read_b128 v[188:191], v247 offset:8192
    s_waitcnt lgkmcnt(7)
    v_mfma_f32_32x32x16_bf16 v[128:143], v[160:163], v[16:19], v[224:239]
    ds_read_b64_tr_b16 v[192:193], v248 offset:0
    ds_read_b64_tr_b16 v[194:195], v248 offset:2048
    s_waitcnt lgkmcnt(8)
    v_mfma_f32_32x32x16_bf16 v[128:143], v[164:167], v[20:23], v[128:143]
    ds_read_b64_tr_b16 v[196:197], v249 offset:0
    ds_read_b64_tr_b16 v[198:199], v249 offset:2048
    s_waitcnt lgkmcnt(9)
    v_mfma_f32_32x32x16_bf16 v[128:143], v[168:171], v[24:27], v[128:143]
    ds_read_b64_tr_b16 v[200:201], v250 offset:0
    ds_read_b64_tr_b16 v[202:203], v250 offset:2048
    s_waitcnt lgkmcnt(10)
    v_mfma_f32_32x32x16_bf16 v[128:143], v[172:175], v[28:31], v[128:143]
    ds_read_b64_tr_b16 v[204:205], v251 offset:0
    ds_read_b64_tr_b16 v[206:207], v251 offset:2048
    v_exp_f32 v112, v112
    v_exp_f32 v113, v113
    v_exp_f32 v114, v114
    v_mov_b32 v9, v112
    s_waitcnt lgkmcnt(11)
    v_mfma_f32_32x32x16_bf16 v[128:143], v[176:179], v[32:35], v[128:143]
    ds_read_b64_tr_b16 v[208:209], v248 offset:4096
    ds_read_b64_tr_b16 v[210:211], v248 offset:6144
    v_exp_f32 v115, v115
    v_mov_b32 v10, v113
    v_exp_f32 v116, v116
    v_add_f32 v9, v9, v114
    s_waitcnt lgkmcnt(12)
    v_mfma_f32_32x32x16_bf16 v[128:143], v[180:183], v[36:39], v[128:143]
    ds_read_b64_tr_b16 v[212:213], v249 offset:4096
    ds_read_b64_tr_b16 v[214:215], v249 offset:6144
    v_exp_f32 v117, v117
    v_add_f32 v10, v10, v115
    v_exp_f32 v118, v118
    v_add_f32 v9, v9, v116
    s_waitcnt lgkmcnt(13)
    v_mfma_f32_32x32x16_bf16 v[128:143], v[184:187], v[40:43], v[128:143]
    v_exp_f32 v119, v119
    v_add_f32 v10, v10, v117
    v_exp_f32 v120, v120
    v_add_f32 v9, v9, v118
    s_waitcnt lgkmcnt(12)
    v_mfma_f32_32x32x16_bf16 v[128:143], v[188:191], v[44:47], v[128:143]
    v_exp_f32 v121, v121
    v_add_f32 v10, v10, v119
    v_exp_f32 v122, v122
    v_add_f32 v9, v9, v120
    s_waitcnt lgkmcnt(10)
    v_mfma_f32_32x32x16_bf16 v[48:63], v[192:195], v[144:147], v[48:63]
    ds_read_b64_tr_b16 v[216:217], v250 offset:4096
    ds_read_b64_tr_b16 v[218:219], v250 offset:6144
    v_exp_f32 v123, v123
    v_add_f32 v10, v10, v121
    v_exp_f32 v124, v124
    s_waitcnt lgkmcnt(10)
    v_mfma_f32_32x32x16_bf16 v[64:79], v[196:199], v[144:147], v[64:79]
    ds_read_b64_tr_b16 v[220:221], v251 offset:4096
    ds_read_b64_tr_b16 v[222:223], v251 offset:6144
    v_add_f32 v9, v9, v122
    v_exp_f32 v125, v125
    v_add_f32 v10, v10, v123
    s_waitcnt lgkmcnt(10)
    v_mfma_f32_32x32x16_bf16 v[80:95], v[200:203], v[144:147], v[80:95]
    ds_read_b64_tr_b16 v[192:193], v248 offset:8192
    ds_read_b64_tr_b16 v[194:195], v248 offset:10240
    v_exp_f32 v126, v126
    v_add_f32 v9, v9, v124
    v_exp_f32 v127, v127
    s_waitcnt lgkmcnt(10)
    v_mfma_f32_32x32x16_bf16 v[96:111], v[204:207], v[144:147], v[96:111]
    ds_read_b64_tr_b16 v[196:197], v249 offset:8192
    ds_read_b64_tr_b16 v[198:199], v249 offset:10240
    v_add_f32 v10, v10, v125
    v_add_f32 v9, v9, v126
    v_add_f32 v10, v10, v127
    s_waitcnt lgkmcnt(10)
    v_mfma_f32_32x32x16_bf16 v[48:63], v[208:211], v[148:151], v[48:63]
    ds_read_b64_tr_b16 v[200:201], v250 offset:8192
    ds_read_b64_tr_b16 v[202:203], v250 offset:10240
    v_exp_f32 v128, v128
    v_exp_f32 v129, v129
    v_exp_f32 v130, v130
    s_waitcnt lgkmcnt(10)
    v_mfma_f32_32x32x16_bf16 v[64:79], v[212:215], v[148:151], v[64:79]
    ds_read_b64_tr_b16 v[204:205], v251 offset:8192
    ds_read_b64_tr_b16 v[206:207], v251 offset:10240
    v_add_f32 v9, v9, v128
    v_exp_f32 v131, v131
    v_add_f32 v10, v10, v129
    s_waitcnt lgkmcnt(10)
    v_mfma_f32_32x32x16_bf16 v[80:95], v[216:219], v[148:151], v[80:95]
    ds_read_b64_tr_b16 v[208:209], v248 offset:12288
    ds_read_b64_tr_b16 v[210:211], v248 offset:14336
    v_exp_f32 v132, v132
    v_add_f32 v9, v9, v130
    v_exp_f32 v133, v133
    s_waitcnt lgkmcnt(10)
    v_mfma_f32_32x32x16_bf16 v[96:111], v[220:223], v[148:151], v[96:111]
    ds_read_b64_tr_b16 v[212:213], v249 offset:12288
    ds_read_b64_tr_b16 v[214:215], v249 offset:14336
    v_add_f32 v10, v10, v131
    v_exp_f32 v134, v134
    v_add_f32 v9, v9, v132
    s_waitcnt lgkmcnt(10)
    v_mfma_f32_32x32x16_bf16 v[48:63], v[192:195], v[152:155], v[48:63]
    ds_read_b64_tr_b16 v[216:217], v250 offset:12288
    ds_read_b64_tr_b16 v[218:219], v250 offset:14336
    v_exp_f32 v135, v135
    v_add_f32 v10, v10, v133
    v_exp_f32 v136, v136
    s_waitcnt lgkmcnt(10)
    v_mfma_f32_32x32x16_bf16 v[64:79], v[196:199], v[152:155], v[64:79]
    ds_read_b64_tr_b16 v[220:221], v251 offset:12288
    ds_read_b64_tr_b16 v[222:223], v251 offset:14336
    v_add_f32 v9, v9, v134
    v_exp_f32 v137, v137
    v_add_f32 v10, v10, v135
    s_waitcnt lgkmcnt(10)
    v_mfma_f32_32x32x16_bf16 v[80:95], v[200:203], v[152:155], v[80:95]
    v_xor_b32 v248, s66, v248
    v_xor_b32 v249, s66, v249
    v_xor_b32 v250, s66, v250
    v_xor_b32 v251, s66, v251
    v_exp_f32 v138, v138
    v_add_f32 v9, v9, v136
    v_exp_f32 v139, v139
    v_add_f32 v10, v10, v137
    v_exp_f32 v140, v140
    s_waitcnt lgkmcnt(8)
    v_mfma_f32_32x32x16_bf16 v[96:111], v[204:207], v[152:155], v[96:111]
    v_add_f32 v9, v9, v138
    v_exp_f32 v141, v141
    v_add_f32 v10, v10, v139
    v_exp_f32 v142, v142
    v_add_f32 v9, v9, v140
    s_waitcnt lgkmcnt(6)
    v_mfma_f32_32x32x16_bf16 v[48:63], v[208:211], v[156:159], v[48:63]
    v_exp_f32 v143, v143
    v_add_f32 v10, v10, v141
    v_add_f32 v9, v9, v142
    v_add_f32 v10, v10, v143
    v_add_f32 v9, v9, v10
    s_waitcnt lgkmcnt(4)
    v_mfma_f32_32x32x16_bf16 v[64:79], v[212:215], v[156:159], v[64:79]
    v_cmp_nge_f32 vcc, s100, v9
    s_waitcnt lgkmcnt(2)
    v_mfma_f32_32x32x16_bf16 v[80:95], v[216:219], v[156:159], v[80:95]
    s_waitcnt lgkmcnt(0)
    v_mfma_f32_32x32x16_bf16 v[96:111], v[220:223], v[156:159], v[96:111]
    s_cbranch_vccz L_joinB
    s_call_b64 s[94:95], L_slow
L_joinB:
    v_add_u32 v14, 1, v14
    ds_write_b32 v13, v14
    ds_read_b32 v254, v12
    v_xor_b32 v240, s65, v240
    v_xor_b32 v241, s65, v241
    v_xor_b32 v242, s65, v242
    v_xor_b32 v243, s65, v243
    v_xor_b32 v244, s65, v244
    v_xor_b32 v245, s65, v245
    v_xor_b32 v246, s65, v246
    v_xor_b32 v247, s65, v247
    ds_read_b128 v[160:163], v240 offset:0
    ds_read_b128 v[164:167], v241 offset:0
    ds_read_b128 v[168:171], v242 offset:0
    ds_read_b128 v[172:175], v243 offset:0
    ds_read_b128 v[176:179], v244 offset:0
    ds_read_b128 v[180:183], v245 offset:0
    ds_read_b128 v[184:187], v246 offset:0
    ds_read_b128 v[188:191], v247 offset:0
    v_cvt_pk_bf16_f32 v144, v112, v113
    v_cvt_pk_bf16_f32 v145, v114, v115
    v_cvt_pk_bf16_f32 v146, v116, v117
    v_cvt_pk_bf16_f32 v147, v118, v119
    v_cvt_pk_bf16_f32 v148, v120, v121
    v_cvt_pk_bf16_f32 v149, v122, v123
    v_cvt_pk_bf16_f32 v150, v124, v125
    v_cvt_pk_bf16_f32 v151, v126, v127
    v_cvt_pk_bf16_f32 v152, v128, v129
    v_cvt_pk_bf16_f32 v153, v130, v131
    v_cvt_pk_bf16_f32 v154, v132, v133
    v_cvt_pk_bf16_f32 v155, v134, v135
    v_cvt_pk_bf16_f32 v156, v136, v137
    v_cvt_pk_bf16_f32 v157, v138, v139
    v_cvt_pk_bf16_f32 v158, v140, v141
    v_cvt_pk_bf16_f32 v159, v142, v143
    v_add_f32 v3, v3, v9
    s_mov_b32 s65, s66
    s_xor_b32 s66, s66, 0x10000
    s_add_u32 s71, s71, 2
    s_add_u32 s64, s64, 1
    s_cmp_lg_u32 s64, 15
    s_cbranch_scc1 L_loopB
L_tail:
    v_mov_b32 v6, v3
    s_nop 1
    v_permlane32_swap_b32 v3, v6
    v_add_f32 v3, v3, v6
    v_rcp_f32 v4, v3
    s_lshl_b32 s73, s61, 5
    s_lshl_b32 s76, s3, 3
    s_add_u32 s73, s73, s76
    s_lshl_b32 s73, s73, 4
    s_add_u32 s73, s73, 12582912
    s_add_u32 s88, s18, s73
    s_addc_u32 s89, s19, 0
    s_movk_i32 s90, 128
    s_mov_b32 s91, 0x20000
    v_and_b32 v253, 7, v0
    v_lshlrev_b32 v253, 4, v253
    buffer_load_dword v11, v253, s[88:91], 0 offen sc1
    s_mov_b32 s71, 32
L_wlf:
    s_waitcnt lgkmcnt(0)
    v_readfirstlane_b32 s73, v254
    s_nop 0
    s_cmp_ge_u32 s73, s71
    s_cbranch_scc1 L_wlf_ok
    s_sub_u32 s72, s72, 1
    s_cbranch_scc1 L_wlf_giveup
    s_sleep 1
    ds_read_b32 v254, v12
    s_branch L_wlf
L_wlf_giveup:
    s_mov_b32 s72, 0
L_wlf_ok:
    ds_read_b64_tr_b16 v[192:193], v248 offset:0
    ds_read_b64_tr_b16 v[194:195], v248 offset:2048
    ds_read_b64_tr_b16 v[196:197], v248 offset:4096
    ds_read_b64_tr_b16 v[198:199], v248 offset:6144
    ds_read_b64_tr_b16 v[200:201], v248 offset:8192
    ds_read_b64_tr_b16 v[202:203], v248 offset:10240
    ds_read_b64_tr_b16 v[204:205], v248 offset:12288
    ds_read_b64_tr_b16 v[206:207], v248 offset:14336
    ds_read_b64_tr_b16 v[208:209], v249 offset:0
    ds_read_b64_tr_b16 v[210:211], v249 offset:2048
    ds_read_b64_tr_b16 v[212:213], v249 offset:4096
    ds_read_b64_tr_b16 v[214:215], v249 offset:6144
    ds_read_b64_tr_b16 v[216:217], v249 offset:8192
    ds_read_b64_tr_b16 v[218:219], v249 offset:10240
    s_waitcnt lgkmcnt(12)
    v_mfma_f32_32x32x16_bf16 v[48:63], v[192:195], v[144:147], v[48:63]
    ds_read_b64_tr_b16 v[220:221], v249 offset:12288
    ds_read_b64_tr_b16 v[222:223], v249 offset:14336
    s_waitcnt lgkmcnt(12)
    v_mfma_f32_32x32x16_bf16 v[48:63], v[196:199], v[148:151], v[48:63]
    ds_read_b64_tr_b16 v[192:193], v250 offset:0
    ds_read_b64_tr_b16 v[194:195], v250 offset:2048
    s_waitcnt lgkmcnt(12)
    v_mfma_f32_32x32x16_bf16 v[48:63], v[200:203], v[152:155], v[48:63]
    ds_read_b64_tr_b16 v[196:197], v250 offset:4096
    ds_read_b64_tr_b16 v[198:199], v250 offset:6144
    s_waitcnt lgkmcnt(12)
    v_mfma_f32_32x32x16_bf16 v[48:63], v[204:207], v[156:159], v[48:63]
    ds_read_b64_tr_b16 v[200:201], v250 offset:8192
    ds_read_b64_tr_b16 v[202:203], v250 offset:10240
    s_waitcnt lgkmcnt(12)
    v_mfma_f32_32x32x16_bf16 v[64:79], v[208:211], v[144:147], v[64:79]
    ds_read_b64_tr_b16 v[204:205], v250 offset:12288
    ds_read_b64_tr_b16 v[206:207], v250 offset:14336
    s_waitcnt lgkmcnt(12)
    v_mfma_f32_32x32x16_bf16 v[64:79], v[212:215], v[148:151], v[64:79]
    ds_read_b64_tr_b16 v[208:209], v251 offset:0
    ds_read_b64_tr_b16 v[210:211], v251 offset:2048
    s_nop 1
    v_mul_f32 v48, v4, v48
    v_mul_f32 v49, v4, v49
    v_mul_f32 v50, v4, v50
    v_mul_f32 v51, v4, v51
    v_mul_f32 v52, v4, v52
    v_mul_f32 v53, v4, v53
    v_mul_f32 v54, v4, v54
    v_mul_f32 v55, v4, v55
    v_cvt_pk_bf16_f32 v112, v48, v49
    s_waitcnt lgkmcnt(12)
    v_mfma_f32_32x32x16_bf16 v[64:79], v[216:219], v[152:155], v[64:79]
    ds_read_b64_tr_b16 v[212:213], v251 offset:4096
    ds_read_b64_tr_b16 v[214:215], v251 offset:6144
    v_cvt_pk_bf16_f32 v113, v50, v51
    v_cvt_pk_bf16_f32 v114, v52, v53
    v_cvt_pk_bf16_f32 v115, v54, v55
    buffer_store_dwordx4 v[112:115], v252, s[44:47], 0 offen offset:0 sc1
    v_mul_f32 v56, v4, v56
    v_mul_f32 v57, v4, v57
    v_mul_f32 v58, v4, v58
    v_mul_f32 v59, v4, v59
    v_mul_f32 v60, v4, v60
    s_waitcnt lgkmcnt(12)
    v_mfma_f32_32x32x16_bf16 v[64:79], v[220:223], v[156:159], v[64:79]
    ds_read_b64_tr_b16 v[216:217], v251 offset:8192
    ds_read_b64_tr_b16 v[218:219], v251 offset:10240
    v_mul_f32 v61, v4, v61
    v_mul_f32 v62, v4, v62
    v_mul_f32 v63, v4, v63
    v_cvt_pk_bf16_f32 v116, v56, v57
    v_cvt_pk_bf16_f32 v117, v58, v59
    v_cvt_pk_bf16_f32 v118, v60, v61
    v_cvt_pk_bf16_f32 v119, v62, v63
    buffer_store_dwordx4 v[116:119], v252, s[44:47], 0 offen offset:512 sc1
    s_waitcnt lgkmcnt(12)
    v_mfma_f32_32x32x16_bf16 v[80:95], v[192:195], v[144:147], v[80:95]
    ds_read_b64_tr_b16 v[220:221], v251 offset:12288
    ds_read_b64_tr_b16 v[222:223], v251 offset:14336
    s_waitcnt lgkmcnt(12)
    v_mfma_f32_32x32x16_bf16 v[80:95], v[196:199], v[148:151], v[80:95]
    v_mul_f32 v64, v4, v64
    v_mul_f32 v65, v4, v65
    v_mul_f32 v66, v4, v66
    v_mul_f32 v67, v4, v67
    v_mul_f32 v68, v4, v68
    v_mul_f32 v69, v4, v69
    v_mul_f32 v70, v4, v70
    v_mul_f32 v71, v4, v71
    v_cvt_pk_bf16_f32 v120, v64, v65
    s_waitcnt lgkmcnt(10)
    v_mfma_f32_32x32x16_bf16 v[80:95], v[200:203], v[152:155], v[80:95]
    v_cvt_pk_bf16_f32 v121, v66, v67
    v_cvt_pk_bf16_f32 v122, v68, v69
    v_cvt_pk_bf16_f32 v123, v70, v71
    buffer_store_dwordx4 v[120:123], v252, s[44:47], 0 offen offset:1024 sc1
    v_mul_f32 v72, v4, v72
    v_mul_f32 v73, v4, v73
    v_mul_f32 v74, v4, v74
    v_mul_f32 v75, v4, v75
    v_mul_f32 v76, v4, v76
    s_waitcnt lgkmcnt(8)
    v_mfma_f32_32x32x16_bf16 v[80:95], v[204:207], v[156:159], v[80:95]
    v_mul_f32 v77, v4, v77
    v_mul_f32 v78, v4, v78
    v_mul_f32 v79, v4, v79
    v_cvt_pk_bf16_f32 v124, v72, v73
    v_cvt_pk_bf16_f32 v125, v74, v75
    v_cvt_pk_bf16_f32 v126, v76, v77
    v_cvt_pk_bf16_f32 v127, v78, v79
    buffer_store_dwordx4 v[124:127], v252, s[44:47], 0 offen offset:1536 sc1
    s_waitcnt lgkmcnt(6)
    v_mfma_f32_32x32x16_bf16 v[96:111], v[208:211], v[144:147], v[96:111]
    s_waitcnt lgkmcnt(4)
    v_mfma_f32_32x32x16_bf16 v[96:111], v[212:215], v[148:151], v[96:111]
    v_mul_f32 v80, v4, v80
    v_mul_f32 v81, v4, v81
    v_mul_f32 v82, v4, v82
    v_mul_f32 v83, v4, v83
    v_mul_f32 v84, v4, v84
    v_mul_f32 v85, v4, v85
    v_mul_f32 v86, v4, v86
    v_mul_f32 v87, v4, v87
    v_cvt_pk_bf16_f32 v128, v80, v81
    s_waitcnt lgkmcnt(2)
    v_mfma_f32_32x32x16_bf16 v[96:111], v[216:219], v[152:155], v[96:111]
    v_cvt_pk_bf16_f32 v129, v82, v83
    v_cvt_pk_bf16_f32 v130, v84, v85
    v_cvt_pk_bf16_f32 v131, v86, v87
    buffer_store_dwordx4 v[128:131], v252, s[44:47], 0 offen offset:2048 sc1
    v_mul_f32 v88, v4, v88
    v_mul_f32 v89, v4, v89
    v_mul_f32 v90, v4, v90
    v_mul_f32 v91, v4, v91
    v_mul_f32 v92, v4, v92
    s_waitcnt lgkmcnt(0)
    v_mfma_f32_32x32x16_bf16 v[96:111], v[220:223], v[156:159], v[96:111]
    v_mul_f32 v93, v4, v93
    v_mul_f32 v94, v4, v94
    v_mul_f32 v95, v4, v95
    v_cvt_pk_bf16_f32 v132, v88, v89
    v_cvt_pk_bf16_f32 v133, v90, v91
    v_cvt_pk_bf16_f32 v134, v92, v93
    v_cvt_pk_bf16_f32 v135, v94, v95
    buffer_store_dwordx4 v[132:135], v252, s[44:47], 0 offen offset:2560 sc1
    s_nop 3
    v_mul_f32 v96, v4, v96
    v_mul_f32 v97, v4, v97
    v_mul_f32 v98, v4, v98
    v_mul_f32 v99, v4, v99
    v_mul_f32 v100, v4, v100
    v_mul_f32 v101, v4, v101
    v_mul_f32 v102, v4, v102
    v_mul_f32 v103, v4, v103
    v_cvt_pk_bf16_f32 v136, v96, v97
    v_cvt_pk_bf16_f32 v137, v98, v99
    v_cvt_pk_bf16_f32 v138, v100, v101
    v_cvt_pk_bf16_f32 v139, v102, v103
    buffer_store_dwordx4 v[136:139], v252, s[44:47], 0 offen offset:3072 sc1
    v_mul_f32 v104, v4, v104
    v_mul_f32 v105, v4, v105
    v_mul_f32 v106, v4, v106
    v_mul_f32 v107, v4, v107
    v_mul_f32 v108, v4, v108
    v_mul_f32 v109, v4, v109
    v_mul_f32 v110, v4, v110
    v_mul_f32 v111, v4, v111
    v_cvt_pk_bf16_f32 v140, v104, v105
    v_cvt_pk_bf16_f32 v141, v106, v107
    v_cvt_pk_bf16_f32 v142, v108, v109
    v_cvt_pk_bf16_f32 v143, v110, v111
    buffer_store_dwordx4 v[140:143], v252, s[44:47], 0 offen offset:3584 sc1
    v_mov_b32 v14, 100
    ds_write_b32 v13, v14
    s_waitcnt vmcnt(8)
    v_cmp_eq_u32 vcc, s78, v11
    s_mov_b32 s71, vcc_lo
    s_mov_b32 s66, 1
L_consume:
    s_mov_b32 s64, 0
    v_mov_b32 v208, 0
    v_mov_b32 v209, 0
    v_mov_b32 v210, 0
    v_mov_b32 v211, 0
    v_mov_b32 v212, 0
    v_mov_b32 v213, 0
    v_mov_b32 v214, 0
    v_mov_b32 v215, 0
    v_mov_b32 v216, 0
    v_mov_b32 v217, 0
    v_mov_b32 v218, 0
    v_mov_b32 v219, 0
    v_mov_b32 v220, 0
    v_mov_b32 v221, 0
    v_mov_b32 v222, 0
    v_mov_b32 v223, 0
    v_mov_b32 v224, 0
    v_mov_b32 v225, 0
    v_mov_b32 v226, 0
    v_mov_b32 v227, 0
    v_mov_b32 v228, 0
    v_mov_b32 v229, 0
    v_mov_b32 v230, 0
    v_mov_b32 v231, 0
L_cloop:
    s_andn2_b32 s65, s71, s64
    s_and_b32 s65, s65, 0xff
    s_cbranch_scc0 L_cidle
    s_bitcmp1_b32 s65, 0
    s_cbranch_scc0 L_nl0
    s_mov_b32 s73, 0
    buffer_load_dwordx4 v[16:19], v1, s[48:51], s73 offen offset:0 sc1
    buffer_load_dwordx4 v[20:23], v1, s[48:51], s73 offen offset:1024 sc1
    buffer_load_dwordx4 v[24:27], v1, s[48:51], s73 offen offset:2048 sc1
    buffer_load_dwordx4 v[28:31], v1, s[48:51], s73 offen offset:3072 sc1
    s_mov_b32 s73, 4096
    buffer_load_dwordx4 v[32:35], v1, s[48:51], s73 offen offset:0 sc1
    buffer_load_dwordx4 v[36:39], v1, s[48:51], s73 offen offset:1024 sc1
    buffer_load_dwordx4 v[40:43], v1, s[48:51], s73 offen offset:2048 sc1
    buffer_load_dwordx4 v[44:47], v1, s[48:51], s73 offen offset:3072 sc1
    s_mov_b32 s73, 8192
    buffer_load_dwordx4 v[48:51], v1, s[48:51], s73 offen offset:0 sc1
    buffer_load_dwordx4 v[52:55], v1, s[48:51], s73 offen offset:1024 sc1
    buffer_load_dwordx4 v[56:59], v1, s[48:51], s73 offen offset:2048 sc1
    buffer_load_dwordx4 v[60:63], v1, s[48:51], s73 offen offset:3072 sc1
L_nl0:
    s_bitcmp1_b32 s65, 1
    s_cbranch_scc0 L_nl1
    s_mov_b32 s73, 24576
    buffer_load_dwordx4 v[64:67], v1, s[48:51], s73 offen offset:0 sc1
    buffer_load_dwordx4 v[68:71], v1, s[48:51], s73 offen offset:1024 sc1
    buffer_load_dwordx4 v[72:75], v1, s[48:51], s73 offen offset:2048 sc1
    buffer_load_dwordx4 v[76:79], v1, s[48:51], s73 offen offset:3072 sc1
    s_mov_b32 s73, 28672
    buffer_load_dwordx4 v[80:83], v1, s[48:51], s73 offen offset:0 sc1
    buffer_load_dwordx4 v[84:87], v1, s[48:51], s73 offen offset:1024 sc1
    buffer_load_dwordx4 v[88:91], v1, s[48:51], s73 offen offset:2048 sc1
    buffer_load_dwordx4 v[92:95], v1, s[48:51], s73 offen offset:3072 sc1
    s_mov_b32 s73, 32768
    buffer_load_dwordx4 v[96:99], v1, s[48:51], s73 offen offset:0 sc1
    buffer_load_dwordx4 v[100:103], v1, s[48:51], s73 offen offset:1024 sc1
    buffer_load_dwordx4 v[104:107], v1, s[48:51], s73 offen offset:2048 sc1
    buffer_load_dwordx4 v[108:111], v1, s[48:51], s73 offen offset:3072 sc1
L_nl1:
    s_cmp_eq_u32 s66, 0
    s_cbranch_scc1 L_npub
    s_bfe_u32 s73, s65, 0x20000
    s_bcnt1_i32_b32 s73, s73
    s_waitcnt vmcnt(24)
    s_cmp_eq_u32 s73, 2
    s_cbranch_scc1 L_cwp
    s_waitcnt vmcnt(12)
    s_cmp_eq_u32 s73, 1
    s_cbranch_scc1 L_cwp
    s_waitcnt vmcnt(0)
L_cwp:
    v_mov_b32 v7, 1
    s_mov_b64 exec, 1
    ds_add_rtn_u32 v8, v12, v7 offset:12
    s_waitcnt lgkmcnt(0)
    v_readfirstlane_b32 s73, v8
    s_nop 0
    s_cmp_lg_u32 s73, 2
    s_cbranch_scc1 L_of_donef
    v_mov_b32 v8, 0
    v_mov_b32 v7, s78
    buffer_store_dword v7, v8, s[28:31], 0 offen sc1
L_of_donef:
    s_mov_b64 exec, -1
    s_mov_b32 s66, 0
L_npub:
    s_bitcmp1_b32 s65, 2
    s_cbranch_scc0 L_nl2
    s_mov_b32 s73, 49152
    buffer_load_dwordx4 v[112:115], v1, s[48:51], s73 offen offset:0 sc1
    buffer_load_dwordx4 v[116:119], v1, s[48:51], s73 offen offset:1024 sc1
    buffer_load_dwordx4 v[120:123], v1, s[48:51], s73 offen offset:2048 sc1
    buffer_load_dwordx4 v[124:127], v1, s[48:51], s73 offen offset:3072 sc1
    s_mov_b32 s73, 53248
    buffer_load_dwordx4 v[128:131], v1, s[48:51], s73 offen offset:0 sc1
    buffer_load_dwordx4 v[132:135], v1, s[48:51], s73 offen offset:1024 sc1
    buffer_load_dwordx4 v[136:139], v1, s[48:51], s73 offen offset:2048 sc1
    buffer_load_dwordx4 v[140:143], v1, s[48:51], s73 offen offset:3072 sc1
    s_mov_b32 s73, 57344
    buffer_load_dwordx4 v[144:147], v1, s[48:51], s73 offen offset:0 sc1
    buffer_load_dwordx4 v[148:151], v1, s[48:51], s73 offen offset:1024 sc1
    buffer_load_dwordx4 v[152:155], v1, s[48:51], s73 offen offset:2048 sc1
    buffer_load_dwordx4 v[156:159], v1, s[48:51], s73 offen offset:3072 sc1
L_nl2:
    s_bitcmp1_b32 s65, 0
    s_cbranch_scc0 L_nm0
    s_bfe_u32 s73, s65, 0x20001
    s_bcnt1_i32_b32 s73, s73
    s_waitcnt vmcnt(24)
    s_cmp_eq_u32 s73, 2
    s_cbranch_scc1 L_cwm0
    s_waitcnt vmcnt(12)
    s_cmp_eq_u32 s73, 1
    s_cbranch_scc1 L_cwm0
    s_waitcnt vmcnt(0)
L_cwm0:
    v_mfma_f32_16x16x32_bf16 v[208:211], a[0:3], v[16:19], v[208:211]
    v_mfma_f32_16x16x32_bf16 v[216:219], a[0:3], v[32:35], v[216:219]
    v_mfma_f32_16x16x32_bf16 v[224:227], a[0:3], v[48:51], v[224:227]
    v_mfma_f32_16x16x32_bf16 v[212:215], a[4:7], v[16:19], v[212:215]
    v_mfma_f32_16x16x32_bf16 v[220:223], a[4:7], v[32:35], v[220:223]
    v_mfma_f32_16x16x32_bf16 v[228:231], a[4:7], v[48:51], v[228:231]
    v_mfma_f32_16x16x32_bf16 v[208:211], a[8:11], v[20:23], v[208:211]
    v_mfma_f32_16x16x32_bf16 v[216:219], a[8:11], v[36:39], v[216:219]
    v_mfma_f32_16x16x32_bf16 v[224:227], a[8:11], v[52:55], v[224:227]
    v_mfma_f32_16x16x32_bf16 v[212:215], a[12:15], v[20:23], v[212:215]
    v_mfma_f32_16x16x32_bf16 v[220:223], a[12:15], v[36:39], v[220:223]
    v_mfma_f32_16x16x32_bf16 v[228:231], a[12:15], v[52:55], v[228:231]
    v_mfma_f32_16x16x32_bf16 v[208:211], a[16:19], v[24:27], v[208:211]
    v_mfma_f32_16x16x32_bf16 v[216:219], a[16:19], v[40:43], v[216:219]
    v_mfma_f32_16x16x32_bf16 v[224:227], a[16:19], v[56:59], v[224:227]
    v_mfma_f32_16x16x32_bf16 v[212:215], a[20:23], v[24:27], v[212:215]
    v_mfma_f32_16x16x32_bf16 v[220:223], a[20:23], v[40:43], v[220:223]
    v_mfma_f32_16x16x32_bf16 v[228:231], a[20:23], v[56:59], v[228:231]
    v_mfma_f32_16x16x32_bf16 v[208:211], a[24:27], v[28:31], v[208:211]
    v_mfma_f32_16x16x32_bf16 v[216:219], a[24:27], v[44:47], v[216:219]
    v_mfma_f32_16x16x32_bf16 v[224:227], a[24:27], v[60:63], v[224:227]
    v_mfma_f32_16x16x32_bf16 v[212:215], a[28:31], v[28:31], v[212:215]
    v_mfma_f32_16x16x32_bf16 v[220:223], a[28:31], v[44:47], v[220:223]
    v_mfma_f32_16x16x32_bf16 v[228:231], a[28:31], v[60:63], v[228:231]
L_nm0:
    s_bitcmp1_b32 s65, 3
    s_cbranch_scc0 L_nl3
    s_mov_b32 s73, 73728
    buffer_load_dwordx4 v[160:163], v1, s[48:51], s73 offen offset:0 sc1
    buffer_load_dwordx4 v[164:167], v1, s[48:51], s73 offen offset:1024 sc1
    buffer_load_dwordx4 v[168:171], v1, s[48:51], s73 offen offset:2048 sc1
    buffer_load_dwordx4 v[172:175], v1, s[48:51], s73 offen offset:3072 sc1
    s_mov_b32 s73, 77824
    buffer_load_dwordx4 v[176:179], v1, s[48:51], s73 offen offset:0 sc1
    buffer_load_dwordx4 v[180:183], v1, s[48:51], s73 offen offset:1024 sc1
    buffer_load_dwordx4 v[184:187], v1, s[48:51], s73 offen offset:2048 sc1
    buffer_load_dwordx4 v[188:191], v1, s[48:51], s73 offen offset:3072 sc1
    s_mov_b32 s73, 81920
    buffer_load_dwordx4 v[192:195], v1, s[48:51], s73 offen offset:0 sc1
    buffer_load_dwordx4 v[196:199], v1, s[48:51], s73 offen offset:1024 sc1
    buffer_load_dwordx4 v[200:203], v1, s[48:51], s73 offen offset:2048 sc1
    buffer_load_dwordx4 v[204:207], v1, s[48:51], s73 offen offset:3072 sc1
L_nl3:
    s_bitcmp1_b32 s65, 1
    s_cbranch_scc0 L_nm1
    s_bfe_u32 s73, s65, 0x20002
    s_bcnt1_i32_b32 s73, s73
    s_waitcnt vmcnt(24)
    s_cmp_eq_u32 s73, 2
    s_cbranch_scc1 L_cwm1
    s_waitcnt vmcnt(12)
    s_cmp_eq_u32 s73, 1
    s_cbranch_scc1 L_cwm1
    s_waitcnt vmcnt(0)
L_cwm1:
    v_mfma_f32_16x16x32_bf16 v[208:211], a[32:35], v[64:67], v[208:211]
    v_mfma_f32_16x16x32_bf16 v[216:219], a[32:35], v[80:83], v[216:219]
    v_mfma_f32_16x16x32_bf16 v[224:227], a[32:35], v[96:99], v[224:227]
    v_mfma_f32_16x16x32_bf16 v[212:215], a[36:39], v[64:67], v[212:215]
    v_mfma_f32_16x16x32_bf16 v[220:223], a[36:39], v[80:83], v[220:223]
    v_mfma_f32_16x16x32_bf16 v[228:231], a[36:39], v[96:99], v[228:231]
    v_mfma_f32_16x16x32_bf16 v[208:211], a[40:43], v[68:71], v[208:211]
    v_mfma_f32_16x16x32_bf16 v[216:219], a[40:43], v[84:87], v[216:219]
    v_mfma_f32_16x16x32_bf16 v[224:227], a[40:43], v[100:103], v[224:227]
    v_mfma_f32_16x16x32_bf16 v[212:215], a[44:47], v[68:71], v[212:215]
    v_mfma_f32_16x16x32_bf16 v[220:223], a[44:47], v[84:87], v[220:223]
    v_mfma_f32_16x16x32_bf16 v[228:231], a[44:47], v[100:103], v[228:231]
    v_mfma_f32_16x16x32_bf16 v[208:211], a[48:51], v[72:75], v[208:211]
    v_mfma_f32_16x16x32_bf16 v[216:219], a[48:51], v[88:91], v[216:219]
    v_mfma_f32_16x16x32_bf16 v[224:227], a[48:51], v[104:107], v[224:227]
    v_mfma_f32_16x16x32_bf16 v[212:215], a[52:55], v[72:75], v[212:215]
    v_mfma_f32_16x16x32_bf16 v[220:223], a[52:55], v[88:91], v[220:223]
    v_mfma_f32_16x16x32_bf16 v[228:231], a[52:55], v[104:107], v[228:231]
    v_mfma_f32_16x16x32_bf16 v[208:211], a[56:59], v[76:79], v[208:211]
    v_mfma_f32_16x16x32_bf16 v[216:219], a[56:59], v[92:95], v[216:219]
    v_mfma_f32_16x16x32_bf16 v[224:227], a[56:59], v[108:111], v[224:227]
    v_mfma_f32_16x16x32_bf16 v[212:215], a[60:63], v[76:79], v[212:215]
    v_mfma_f32_16x16x32_bf16 v[220:223], a[60:63], v[92:95], v[220:223]
    v_mfma_f32_16x16x32_bf16 v[228:231], a[60:63], v[108:111], v[228:231]
L_nm1:
    s_bitcmp1_b32 s65, 4
    s_cbranch_scc0 L_nl4
    s_mov_b32 s73, 98304
    buffer_load_dwordx4 v[16:19], v1, s[48:51], s73 offen offset:0 sc1
    buffer_load_dwordx4 v[20:23], v1, s[48:51], s73 offen offset:1024 sc1
    buffer_load_dwordx4 v[24:27], v1, s[48:51], s73 offen offset:2048 sc1
    buffer_load_dwordx4 v[28:31], v1, s[48:51], s73 offen offset:3072 sc1
    s_mov_b32 s73, 102400
    buffer_load_dwordx4 v[32:35], v1, s[48:51], s73 offen offset:0 sc1
    buffer_load_dwordx4 v[36:39], v1, s[48:51], s73 offen offset:1024 sc1
    buffer_load_dwordx4 v[40:43], v1, s[48:51], s73 offen offset:2048 sc1
    buffer_load_dwordx4 v[44:47], v1, s[48:51], s73 offen offset:3072 sc1
    s_mov_b32 s73, 106496
    buffer_load_dwordx4 v[48:51], v1, s[48:51], s73 offen offset:0 sc1
    buffer_load_dwordx4 v[52:55], v1, s[48:51], s73 offen offset:1024 sc1
    buffer_load_dwordx4 v[56:59], v1, s[48:51], s73 offen offset:2048 sc1
    buffer_load_dwordx4 v[60:63], v1, s[48:51], s73 offen offset:3072 sc1
L_nl4:
    s_bitcmp1_b32 s65, 2
    s_cbranch_scc0 L_nm2
    s_bfe_u32 s73, s65, 0x20003
    s_bcnt1_i32_b32 s73, s73
    s_waitcnt vmcnt(24)
    s_cmp_eq_u32 s73, 2
    s_cbranch_scc1 L_cwm2
    s_waitcnt vmcnt(12)
    s_cmp_eq_u32 s73, 1
    s_cbranch_scc1 L_cwm2
    s_waitcnt vmcnt(0)
L_cwm2:
    v_mfma_f32_16x16x32_bf16 v[208:211], a[64:67], v[112:115], v[208:211]
    v_mfma_f32_16x16x32_bf16 v[216:219], a[64:67], v[128:131], v[216:219]
    v_mfma_f32_16x16x32_bf16 v[224:227], a[64:67], v[144:147], v[224:227]
    v_mfma_f32_16x16x32_bf16 v[212:215], a[68:71], v[112:115], v[212:215]
    v_mfma_f32_16x16x32_bf16 v[220:223], a[68:71], v[128:131], v[220:223]
    v_mfma_f32_16x16x32_bf16 v[228:231], a[68:71], v[144:147], v[228:231]
    v_mfma_f32_16x16x32_bf16 v[208:211], a[72:75], v[116:119], v[208:211]
    v_mfma_f32_16x16x32_bf16 v[216:219], a[72:75], v[132:135], v[216:219]
    v_mfma_f32_16x16x32_bf16 v[224:227], a[72:75], v[148:151], v[224:227]
    v_mfma_f32_16x16x32_bf16 v[212:215], a[76:79], v[116:119], v[212:215]
    v_mfma_f32_16x16x32_bf16 v[220:223], a[76:79], v[132:135], v[220:223]
    v_mfma_f32_16x16x32_bf16 v[228:231], a[76:79], v[148:151], v[228:231]
    v_mfma_f32_16x16x32_bf16 v[208:211], a[80:83], v[120:123], v[208:211]
    v_mfma_f32_16x16x32_bf16 v[216:219], a[80:83], v[136:139], v[216:219]
    v_mfma_f32_16x16x32_bf16 v[224:227], a[80:83], v[152:155], v[224:227]
    v_mfma_f32_16x16x32_bf16 v[212:215], a[84:87], v[120:123], v[212:215]
    v_mfma_f32_16x16x32_bf16 v[220:223], a[84:87], v[136:139], v[220:223]
    v_mfma_f32_16x16x32_bf16 v[228:231], a[84:87], v[152:155], v[228:231]
    v_mfma_f32_16x16x32_bf16 v[208:211], a[88:91], v[124:127], v[208:211]
    v_mfma_f32_16x16x32_bf16 v[216:219], a[88:91], v[140:143], v[216:219]
    v_mfma_f32_16x16x32_bf16 v[224:227], a[88:91], v[156:159], v[224:227]
    v_mfma_f32_16x16x32_bf16 v[212:215], a[92:95], v[124:127], v[212:215]
    v_mfma_f32_16x16x32_bf16 v[220:223], a[92:95], v[140:143], v[220:223]
    v_mfma_f32_16x16x32_bf16 v[228:231], a[92:95], v[156:159], v[228:231]
L_nm2:
    s_bitcmp1_b32 s65, 5
    s_cbranch_scc0 L_nl5
    s_mov_b32 s73, 122880
    buffer_load_dwordx4 v[64:67], v1, s[48:51], s73 offen offset:0 sc1
    buffer_load_dwordx4 v[68:71], v1, s[48:51], s73 offen offset:1024 sc1
    buffer_load_dwordx4 v[72:75], v1, s[48:51], s73 offen offset:2048 sc1
    buffer_load_dwordx4 v[76:79], v1, s[48:51], s73 offen offset:3072 sc1
    s_mov_b32 s73, 126976
    buffer_load_dwordx4 v[80:83], v1, s[48:51], s73 offen offset:0 sc1
    buffer_load_dwordx4 v[84:87], v1, s[48:51], s73 offen offset:1024 sc1
    buffer_load_dwordx4 v[88:91], v1, s[48:51], s73 offen offset:2048 sc1
    buffer_load_dwordx4 v[92:95], v1, s[48:51], s73 offen offset:3072 sc1
    s_mov_b32 s73, 131072
    buffer_load_dwordx4 v[96:99], v1, s[48:51], s73 offen offset:0 sc1
    buffer_load_dwordx4 v[100:103], v1, s[48:51], s73 offen offset:1024 sc1
    buffer_load_dwordx4 v[104:107], v1, s[48:51], s73 offen offset:2048 sc1
    buffer_load_dwordx4 v[108:111], v1, s[48:51], s73 offen offset:3072 sc1
L_nl5:
    s_bitcmp1_b32 s65, 3
    s_cbranch_scc0 L_nm3
    s_bfe_u32 s73, s65, 0x20004
    s_bcnt1_i32_b32 s73, s73
    s_waitcnt vmcnt(24)
    s_cmp_eq_u32 s73, 2
    s_cbranch_scc1 L_cwm3
    s_waitcnt vmcnt(12)
    s_cmp_eq_u32 s73, 1
    s_cbranch_scc1 L_cwm3
    s_waitcnt vmcnt(0)
L_cwm3:
    v_mfma_f32_16x16x32_bf16 v[208:211], a[96:99], v[160:163], v[208:211]
    v_mfma_f32_16x16x32_bf16 v[216:219], a[96:99], v[176:179], v[216:219]
    v_mfma_f32_16x16x32_bf16 v[224:227], a[96:99], v[192:195], v[224:227]
    v_mfma_f32_16x16x32_bf16 v[212:215], a[100:103], v[160:163], v[212:215]
    v_mfma_f32_16x16x32_bf16 v[220:223], a[100:103], v[176:179], v[220:223]
    v_mfma_f32_16x16x32_bf16 v[228:231], a[100:103], v[192:195], v[228:231]
    v_mfma_f32_16x16x32_bf16 v[208:211], a[104:107], v[164:167], v[208:211]
    v_mfma_f32_16x16x32_bf16 v[216:219], a[104:107], v[180:183], v[216:219]
    v_mfma_f32_16x16x32_bf16 v[224:227], a[104:107], v[196:199], v[224:227]
    v_mfma_f32_16x16x32_bf16 v[212:215], a[108:111], v[164:167], v[212:215]
    v_mfma_f32_16x16x32_bf16 v[220:223], a[108:111], v[180:183], v[220:223]
    v_mfma_f32_16x16x32_bf16 v[228:231], a[108:111], v[196:199], v[228:231]
    v_mfma_f32_16x16x32_bf16 v[208:211], a[112:115], v[168:171], v[208:211]
    v_mfma_f32_16x16x32_bf16 v[216:219], a[112:115], v[184:187], v[216:219]
    v_mfma_f32_16x16x32_bf16 v[224:227], a[112:115], v[200:203], v[224:227]
    v_mfma_f32_16x16x32_bf16 v[212:215], a[116:119], v[168:171], v[212:215]
    v_mfma_f32_16x16x32_bf16 v[220:223], a[116:119], v[184:187], v[220:223]
    v_mfma_f32_16x16x32_bf16 v[228:231], a[116:119], v[200:203], v[228:231]
    v_mfma_f32_16x16x32_bf16 v[208:211], a[120:123], v[172:175], v[208:211]
    v_mfma_f32_16x16x32_bf16 v[216:219], a[120:123], v[188:191], v[216:219]
    v_mfma_f32_16x16x32_bf16 v[224:227], a[120:123], v[204:207], v[224:227]
    v_mfma_f32_16x16x32_bf16 v[212:215], a[124:127], v[172:175], v[212:215]
    v_mfma_f32_16x16x32_bf16 v[220:223], a[124:127], v[188:191], v[220:223]
    v_mfma_f32_16x16x32_bf16 v[228:231], a[124:127], v[204:207], v[228:231]
L_nm3:
    s_bitcmp1_b32 s65, 6
    s_cbranch_scc0 L_nl6
    s_mov_b32 s73, 147456
    buffer_load_dwordx4 v[112:115], v1, s[48:51], s73 offen offset:0 sc1
    buffer_load_dwordx4 v[116:119], v1, s[48:51], s73 offen offset:1024 sc1
    buffer_load_dwordx4 v[120:123], v1, s[48:51], s73 offen offset:2048 sc1
    buffer_load_dwordx4 v[124:127], v1, s[48:51], s73 offen offset:3072 sc1
    s_mov_b32 s73, 151552
    buffer_load_dwordx4 v[128:131], v1, s[48:51], s73 offen offset:0 sc1
    buffer_load_dwordx4 v[132:135], v1, s[48:51], s73 offen offset:1024 sc1
    buffer_load_dwordx4 v[136:139], v1, s[48:51], s73 offen offset:2048 sc1
    buffer_load_dwordx4 v[140:143], v1, s[48:51], s73 offen offset:3072 sc1
    s_mov_b32 s73, 155648
    buffer_load_dwordx4 v[144:147], v1, s[48:51], s73 offen offset:0 sc1
    buffer_load_dwordx4 v[148:151], v1, s[48:51], s73 offen offset:1024 sc1
    buffer_load_dwordx4 v[152:155], v1, s[48:51], s73 offen offset:2048 sc1
    buffer_load_dwordx4 v[156:159], v1, s[48:51], s73 offen offset:3072 sc1
L_nl6:
    s_bitcmp1_b32 s65, 4
    s_cbranch_scc0 L_nm4
    s_bfe_u32 s73, s65, 0x20005
    s_bcnt1_i32_b32 s73, s73
    s_waitcnt vmcnt(24)
    s_cmp_eq_u32 s73, 2
    s_cbranch_scc1 L_cwm4
    s_waitcnt vmcnt(12)
    s_cmp_eq_u32 s73, 1
    s_cbranch_scc1 L_cwm4
    s_waitcnt vmcnt(0)
L_cwm4:
    v_mfma_f32_16x16x32_bf16 v[208:211], a[128:131], v[16:19], v[208:211]
    v_mfma_f32_16x16x32_bf16 v[216:219], a[128:131], v[32:35], v[216:219]
    v_mfma_f32_16x16x32_bf16 v[224:227], a[128:131], v[48:51], v[224:227]
    v_mfma_f32_16x16x32_bf16 v[212:215], a[132:135], v[16:19], v[212:215]
    v_mfma_f32_16x16x32_bf16 v[220:223], a[132:135], v[32:35], v[220:223]
    v_mfma_f32_16x16x32_bf16 v[228:231], a[132:135], v[48:51], v[228:231]
    v_mfma_f32_16x16x32_bf16 v[208:211], a[136:139], v[20:23], v[208:211]
    v_mfma_f32_16x16x32_bf16 v[216:219], a[136:139], v[36:39], v[216:219]
    v_mfma_f32_16x16x32_bf16 v[224:227], a[136:139], v[52:55], v[224:227]
    v_mfma_f32_16x16x32_bf16 v[212:215], a[140:143], v[20:23], v[212:215]
    v_mfma_f32_16x16x32_bf16 v[220:223], a[140:143], v[36:39], v[220:223]
    v_mfma_f32_16x16x32_bf16 v[228:231], a[140:143], v[52:55], v[228:231]
    v_mfma_f32_16x16x32_bf16 v[208:211], a[144:147], v[24:27], v[208:211]
    v_mfma_f32_16x16x32_bf16 v[216:219], a[144:147], v[40:43], v[216:219]
    v_mfma_f32_16x16x32_bf16 v[224:227], a[144:147], v[56:59], v[224:227]
    v_mfma_f32_16x16x32_bf16 v[212:215], a[148:151], v[24:27], v[212:215]
    v_mfma_f32_16x16x32_bf16 v[220:223], a[148:151], v[40:43], v[220:223]
    v_mfma_f32_16x16x32_bf16 v[228:231], a[148:151], v[56:59], v[228:231]
    v_mfma_f32_16x16x32_bf16 v[208:211], a[152:155], v[28:31], v[208:211]
    v_mfma_f32_16x16x32_bf16 v[216:219], a[152:155], v[44:47], v[216:219]
    v_mfma_f32_16x16x32_bf16 v[224:227], a[152:155], v[60:63], v[224:227]
    v_mfma_f32_16x16x32_bf16 v[212:215], a[156:159], v[28:31], v[212:215]
    v_mfma_f32_16x16x32_bf16 v[220:223], a[156:159], v[44:47], v[220:223]
    v_mfma_f32_16x16x32_bf16 v[228:231], a[156:159], v[60:63], v[228:231]
L_nm4:
    s_bitcmp1_b32 s65, 7
    s_cbranch_scc0 L_nl7
    s_mov_b32 s73, 172032
    buffer_load_dwordx4 v[160:163], v1, s[48:51], s73 offen offset:0 sc1
    buffer_load_dwordx4 v[164:167], v1, s[48:51], s73 offen offset:1024 sc1
    buffer_load_dwordx4 v[168:171], v1, s[48:51], s73 offen offset:2048 sc1
    buffer_load_dwordx4 v[172:175], v1, s[48:51], s73 offen offset:3072 sc1
    s_mov_b32 s73, 176128
    buffer_load_dwordx4 v[176:179], v1, s[48:51], s73 offen offset:0 sc1
    buffer_load_dwordx4 v[180:183], v1, s[48:51], s73 offen offset:1024 sc1
    buffer_load_dwordx4 v[184:187], v1, s[48:51], s73 offen offset:2048 sc1
    buffer_load_dwordx4 v[188:191], v1, s[48:51], s73 offen offset:3072 sc1
    s_mov_b32 s73, 180224
    buffer_load_dwordx4 v[192:195], v1, s[48:51], s73 offen offset:0 sc1
    buffer_load_dwordx4 v[196:199], v1, s[48:51], s73 offen offset:1024 sc1
    buffer_load_dwordx4 v[200:203], v1, s[48:51], s73 offen offset:2048 sc1
    buffer_load_dwordx4 v[204:207], v1, s[48:51], s73 offen offset:3072 sc1
L_nl7:
    s_bitcmp1_b32 s65, 5
    s_cbranch_scc0 L_nm5
    s_bfe_u32 s73, s65, 0x20006
    s_bcnt1_i32_b32 s73, s73
    s_waitcnt vmcnt(24)
    s_cmp_eq_u32 s73, 2
    s_cbranch_scc1 L_cwm5
    s_waitcnt vmcnt(12)
    s_cmp_eq_u32 s73, 1
    s_cbranch_scc1 L_cwm5
    s_waitcnt vmcnt(0)
L_cwm5:
    v_mfma_f32_16x16x32_bf16 v[208:211], a[160:163], v[64:67], v[208:211]
    v_mfma_f32_16x16x32_bf16 v[216:219], a[160:163], v[80:83], v[216:219]
    v_mfma_f32_16x16x32_bf16 v[224:227], a[160:163], v[96:99], v[224:227]
    v_mfma_f32_16x16x32_bf16 v[212:215], a[164:167], v[64:67], v[212:215]
    v_mfma_f32_16x16x32_bf16 v[220:223], a[164:167], v[80:83], v[220:223]
    v_mfma_f32_16x16x32_bf16 v[228:231], a[164:167], v[96:99], v[228:231]
    v_mfma_f32_16x16x32_bf16 v[208:211], a[168:171], v[68:71], v[208:211]
    v_mfma_f32_16x16x32_bf16 v[216:219], a[168:171], v[84:87], v[216:219]
    v_mfma_f32_16x16x32_bf16 v[224:227], a[168:171], v[100:103], v[224:227]
    v_mfma_f32_16x16x32_bf16 v[212:215], a[172:175], v[68:71], v[212:215]
    v_mfma_f32_16x16x32_bf16 v[220:223], a[172:175], v[84:87], v[220:223]
    v_mfma_f32_16x16x32_bf16 v[228:231], a[172:175], v[100:103], v[228:231]
    v_mfma_f32_16x16x32_bf16 v[208:211], a[176:179], v[72:75], v[208:211]
    v_mfma_f32_16x16x32_bf16 v[216:219], a[176:179], v[88:91], v[216:219]
    v_mfma_f32_16x16x32_bf16 v[224:227], a[176:179], v[104:107], v[224:227]
    v_mfma_f32_16x16x32_bf16 v[212:215], a[180:183], v[72:75], v[212:215]
    v_mfma_f32_16x16x32_bf16 v[220:223], a[180:183], v[88:91], v[220:223]
    v_mfma_f32_16x16x32_bf16 v[228:231], a[180:183], v[104:107], v[228:231]
    v_mfma_f32_16x16x32_bf16 v[208:211], a[184:187], v[76:79], v[208:211]
    v_mfma_f32_16x16x32_bf16 v[216:219], a[184:187], v[92:95], v[216:219]
    v_mfma_f32_16x16x32_bf16 v[224:227], a[184:187], v[108:111], v[224:227]
    v_mfma_f32_16x16x32_bf16 v[212:215], a[188:191], v[76:79], v[212:215]
    v_mfma_f32_16x16x32_bf16 v[220:223], a[188:191], v[92:95], v[220:223]
    v_mfma_f32_16x16x32_bf16 v[228:231], a[188:191], v[108:111], v[228:231]
L_nm5:
    s_bitcmp1_b32 s65, 6
    s_cbranch_scc0 L_nm6
    s_bfe_u32 s73, s65, 0x10007
    s_bcnt1_i32_b32 s73, s73
    s_waitcnt vmcnt(12)
    s_cmp_eq_u32 s73, 1
    s_cbranch_scc1 L_cwm6
    s_waitcnt vmcnt(0)
L_cwm6:
    v_mfma_f32_16x16x32_bf16 v[208:211], a[192:195], v[112:115], v[208:211]
    v_mfma_f32_16x16x32_bf16 v[216:219], a[192:195], v[128:131], v[216:219]
    v_mfma_f32_16x16x32_bf16 v[224:227], a[192:195], v[144:147], v[224:227]
    v_mfma_f32_16x16x32_bf16 v[212:215], a[196:199], v[112:115], v[212:215]
    v_mfma_f32_16x16x32_bf16 v[220:223], a[196:199], v[128:131], v[220:223]
    v_mfma_f32_16x16x32_bf16 v[228:231], a[196:199], v[144:147], v[228:231]
    v_mfma_f32_16x16x32_bf16 v[208:211], a[200:203], v[116:119], v[208:211]
    v_mfma_f32_16x16x32_bf16 v[216:219], a[200:203], v[132:135], v[216:219]
    v_mfma_f32_16x16x32_bf16 v[224:227], a[200:203], v[148:151], v[224:227]
    v_mfma_f32_16x16x32_bf16 v[212:215], a[204:207], v[116:119], v[212:215]
    v_mfma_f32_16x16x32_bf16 v[220:223], a[204:207], v[132:135], v[220:223]
    v_mfma_f32_16x16x32_bf16 v[228:231], a[204:207], v[148:151], v[228:231]
    v_mfma_f32_16x16x32_bf16 v[208:211], a[208:211], v[120:123], v[208:211]
    v_mfma_f32_16x16x32_bf16 v[216:219], a[208:211], v[136:139], v[216:219]
    v_mfma_f32_16x16x32_bf16 v[224:227], a[208:211], v[152:155], v[224:227]
    v_mfma_f32_16x16x32_bf16 v[212:215], a[212:215], v[120:123], v[212:215]
    v_mfma_f32_16x16x32_bf16 v[220:223], a[212:215], v[136:139], v[220:223]
    v_mfma_f32_16x16x32_bf16 v[228:231], a[212:215], v[152:155], v[228:231]
    v_mfma_f32_16x16x32_bf16 v[208:211], a[216:219], v[124:127], v[208:211]
    v_mfma_f32_16x16x32_bf16 v[216:219], a[216:219], v[140:143], v[216:219]
    v_mfma_f32_16x16x32_bf16 v[224:227], a[216:219], v[156:159], v[224:227]
    v_mfma_f32_16x16x32_bf16 v[212:215], a[220:223], v[124:127], v[212:215]
    v_mfma_f32_16x16x32_bf16 v[220:223], a[220:223], v[140:143], v[220:223]
    v_mfma_f32_16x16x32_bf16 v[228:231], a[220:223], v[156:159], v[228:231]
L_nm6:
    s_bitcmp1_b32 s65, 7
    s_cbranch_scc0 L_nm7
    s_waitcnt vmcnt(0)
    v_mfma_f32_16x16x32_bf16 v[208:211], a[224:227], v[160:163], v[208:211]
    v_mfma_f32_16x16x32_bf16 v[216:219], a[224:227], v[176:179], v[216:219]
    v_mfma_f32_16x16x32_bf16 v[224:227], a[224:227], v[192:195], v[224:227]
    v_mfma_f32_16x16x32_bf16 v[212:215], a[228:231], v[160:163], v[212:215]
    v_mfma_f32_16x16x32_bf16 v[220:223], a[228:231], v[176:179], v[220:223]
    v_mfma_f32_16x16x32_bf16 v[228:231], a[228:231], v[192:195], v[228:231]
    v_mfma_f32_16x16x32_bf16 v[208:211], a[232:235], v[164:167], v[208:211]
    v_mfma_f32_16x16x32_bf16 v[216:219], a[232:235], v[180:183], v[216:219]
    v_mfma_f32_16x16x32_bf16 v[224:227], a[232:235], v[196:199], v[224:227]
    v_mfma_f32_16x16x32_bf16 v[212:215], a[236:239], v[164:167], v[212:215]
    v_mfma_f32_16x16x32_bf16 v[220:223], a[236:239], v[180:183], v[220:223]
    v_mfma_f32_16x16x32_bf16 v[228:231], a[236:239], v[196:199], v[228:231]
    v_mfma_f32_16x16x32_bf16 v[208:211], a[240:243], v[168:171], v[208:211]
    v_mfma_f32_16x16x32_bf16 v[216:219], a[240:243], v[184:187], v[216:219]
    v_mfma_f32_16x16x32_bf16 v[224:227], a[240:243], v[200:203], v[224:227]
    v_mfma_f32_16x16x32_bf16 v[212:215], a[244:247], v[168:171], v[212:215]
    v_mfma_f32_16x16x32_bf16 v[220:223], a[244:247], v[184:187], v[220:223]
    v_mfma_f32_16x16x32_bf16 v[228:231], a[244:247], v[200:203], v[228:231]
    v_mfma_f32_16x16x32_bf16 v[208:211], a[248:251], v[172:175], v[208:211]
    v_mfma_f32_16x16x32_bf16 v[216:219], a[248:251], v[188:191], v[216:219]
    v_mfma_f32_16x16x32_bf16 v[224:227], a[248:251], v[204:207], v[224:227]
    v_mfma_f32_16x16x32_bf16 v[212:215], a[252:255], v[172:175], v[212:215]
    v_mfma_f32_16x16x32_bf16 v[220:223], a[252:255], v[188:191], v[220:223]
    v_mfma_f32_16x16x32_bf16 v[228:231], a[252:255], v[204:207], v[228:231]
L_nm7:
    s_or_b32 s64, s64, s65
    s_cmp_lg_u32 s64, 0xff
    s_cbranch_scc1 L_cpoll
L_cfin:
    s_nop 7
    s_mul_i32 s73, s3, 6144
    s_add_u32 s73, s73, 131072
    v_add_u32 v2, s73, v1
    ds_write_b128 v2, v[208:211] offset:0
    ds_write_b128 v2, v[212:215] offset:1024
    ds_write_b128 v2, v[216:219] offset:2048
    ds_write_b128 v2, v[220:223] offset:3072
    ds_write_b128 v2, v[224:227] offset:4096
    ds_write_b128 v2, v[228:231] offset:5120
    s_waitcnt lgkmcnt(0)
    s_barrier
    s_cmp_eq_u32 s3, 3
    s_cbranch_scc1 L_done
    s_lshl_b32 s73, s3, 11
    s_add_u32 s73, s73, 131072
    v_add_u32 v2, s73, v1
    ds_read_b128 v[16:19], v2 offset:0
    ds_read_b128 v[20:23], v2 offset:1024
    ds_read_b128 v[24:27], v2 offset:6144
    ds_read_b128 v[28:31], v2 offset:7168
    ds_read_b128 v[32:35], v2 offset:12288
    ds_read_b128 v[36:39], v2 offset:13312
    ds_read_b128 v[40:43], v2 offset:18432
    ds_read_b128 v[44:47], v2 offset:19456
    v_and_b32 v3, 15, v0
    v_lshlrev_b32 v3, 10, v3
    v_lshrrev_b32 v4, 4, v0
    v_lshl_add_u32 v3, v4, 3, v3
    s_lshl_b32 s73, s3, 14
    v_add_u32 v3, s73, v3
    s_waitcnt lgkmcnt(0)
    v_add_f32 v16, v16, v24
    v_add_f32 v32, v32, v40
    v_add_f32 v17, v17, v25
    v_add_f32 v33, v33, v41
    v_add_f32 v18, v18, v26
    v_add_f32 v34, v34, v42
    v_add_f32 v19, v19, v27
    v_add_f32 v35, v35, v43
    v_add_f32 v16, v16, v32
    v_add_f32 v17, v17, v33
    v_add_f32 v18, v18, v34
    v_add_f32 v19, v19, v35
    v_cvt_pk_bf16_f32 v48, v16, v17
    v_cvt_pk_bf16_f32 v49, v18, v19
    buffer_store_dwordx2 v[48:49], v3, s[40:43], 0 offen offset:0 sc1
    v_add_f32 v20, v20, v28
    v_add_f32 v36, v36, v44
    v_add_f32 v21, v21, v29
    v_add_f32 v37, v37, v45
    v_add_f32 v22, v22, v30
    v_add_f32 v38, v38, v46
    v_add_f32 v23, v23, v31
    v_add_f32 v39, v39, v47
    v_add_f32 v20, v20, v36
    v_add_f32 v21, v21, v37
    v_add_f32 v22, v22, v38
    v_add_f32 v23, v23, v39
    v_cvt_pk_bf16_f32 v50, v20, v21
    v_cvt_pk_bf16_f32 v51, v22, v23
    buffer_store_dwordx2 v[50:51], v3, s[40:43], 0 offen offset:32 sc1
L_done:
L_end:
    s_endpgm
L_cidle:
    s_cmp_eq_u32 s66, 0
    s_cbranch_scc1 L_cidle2
    s_waitcnt vmcnt(0)
    v_mov_b32 v7, 1
    s_mov_b64 exec, 1
    ds_add_rtn_u32 v8, v12, v7 offset:12
    s_waitcnt lgkmcnt(0)
    v_readfirstlane_b32 s73, v8
    s_nop 0
    s_cmp_lg_u32 s73, 2
    s_cbranch_scc1 L_of_dones
    v_mov_b32 v8, 0
    v_mov_b32 v7, s78
    buffer_store_dword v7, v8, s[28:31], 0 offen sc1
L_of_dones:
    s_mov_b64 exec, -1
    s_mov_b32 s66, 0
    s_branch L_cpoll
L_cidle2:
    s_sub_u32 s72, s72, 50
    s_cbranch_scc1 L_cgu
    s_sleep 4
L_cpoll:
    buffer_load_dword v3, v253, s[88:91], 0 offen sc1
    s_waitcnt vmcnt(0)
    v_cmp_eq_u32 vcc, s78, v3
    s_mov_b32 s71, vcc_lo
    s_branch L_cloop
L_cgu:
    s_mov_b32 s72, 0
    s_movk_i32 s71, 0xff
    s_branch L_cloop
L_slow:
    ds_read_b128 v[160:163], v240 offset:0
    ds_read_b128 v[164:167], v241 offset:0
    ds_read_b128 v[168:171], v242 offset:0
    ds_read_b128 v[172:175], v243 offset:0
    ds_read_b128 v[176:179], v244 offset:0
    ds_read_b128 v[180:183], v245 offset:0
    ds_read_b128 v[184:187], v246 offset:0
    ds_read_b128 v[188:191], v247 offset:0
    s_waitcnt lgkmcnt(7)
    v_mfma_f32_32x32x16_bf16 v[112:127], v[160:163], v[16:19], 0
    ds_read_b128 v[160:163], v240 offset:8192
    s_waitcnt lgkmcnt(7)
    v_mfma_f32_32x32x16_bf16 v[112:127], v[164:167], v[20:23], v[112:127]
    ds_read_b128 v[164:167], v241 offset:8192
    s_waitcnt lgkmcnt(7)
    v_mfma_f32_32x32x16_bf16 v[112:127], v[168:171], v[24:27], v[112:127]
    ds_read_b128 v[168:171], v242 offset:8192
    s_waitcnt lgkmcnt(7)
    v_mfma_f32_32x32x16_bf16 v[112:127], v[172:175], v[28:31], v[112:127]
    ds_read_b128 v[172:175], v243 offset:8192
    s_waitcnt lgkmcnt(7)
    v_mfma_f32_32x32x16_bf16 v[112:127], v[176:179], v[32:35], v[112:127]
    ds_read_b128 v[176:179], v244 offset:8192
    s_waitcnt lgkmcnt(7)
    v_mfma_f32_32x32x16_bf16 v[112:127], v[180:183], v[36:39], v[112:127]
    ds_read_b128 v[180:183], v245 offset:8192
    s_waitcnt lgkmcnt(7)
    v_mfma_f32_32x32x16_bf16 v[112:127], v[184:187], v[40:43], v[112:127]
    ds_read_b128 v[184:187], v246 offset:8192
    s_waitcnt lgkmcnt(7)
    v_mfma_f32_32x32x16_bf16 v[112:127], v[188:191], v[44:47], v[112:127]
    ds_read_b128 v[188:191], v247 offset:8192
    s_waitcnt lgkmcnt(7)
    v_mfma_f32_32x32x16_bf16 v[128:143], v[160:163], v[16:19], 0
    s_waitcnt lgkmcnt(6)
    v_mfma_f32_32x32x16_bf16 v[128:143], v[164:167], v[20:23], v[128:143]
    s_waitcnt lgkmcnt(5)
    v_mfma_f32_32x32x16_bf16 v[128:143], v[168:171], v[24:27], v[128:143]
    s_waitcnt lgkmcnt(4)
    v_mfma_f32_32x32x16_bf16 v[128:143], v[172:175], v[28:31], v[128:143]
    s_waitcnt lgkmcnt(3)
    v_mfma_f32_32x32x16_bf16 v[128:143], v[176:179], v[32:35], v[128:143]
    s_waitcnt lgkmcnt(2)
    v_mfma_f32_32x32x16_bf16 v[128:143], v[180:183], v[36:39], v[128:143]
    s_waitcnt lgkmcnt(1)
    v_mfma_f32_32x32x16_bf16 v[128:143], v[184:187], v[40:43], v[128:143]
    s_waitcnt lgkmcnt(0)
    v_mfma_f32_32x32x16_bf16 v[128:143], v[188:191], v[44:47], v[128:143]
    v_max3_f32 v5, v112, v113, v114
    v_max3_f32 v5, v5, v115, v116
    v_max3_f32 v5, v5, v117, v118
    v_max3_f32 v5, v5, v119, v120
    v_max3_f32 v5, v5, v121, v122
    v_max3_f32 v5, v5, v123, v124
    v_max3_f32 v5, v5, v125, v126
    s_nop 4
    v_max3_f32 v5, v5, v127, v128
    v_max3_f32 v5, v5, v129, v130
    v_max3_f32 v5, v5, v131, v132
    v_max3_f32 v5, v5, v133, v134
    v_max3_f32 v5, v5, v135, v136
    v_max3_f32 v5, v5, v137, v138
    v_max3_f32 v5, v5, v139, v140
    v_max3_f32 v5, v5, v141, v142
    v_max_f32 v5, v5, v143
    v_mov_b32 v6, v5
    s_nop 1
    v_permlane32_swap_b32 v5, v6
    v_max3_f32 v7, v5, v6, v2
    v_sub_f32 v4, v2, v7
    v_mov_b32 v2, v7
    v_exp_f32 v4, v4
    v_sub_f32 v224, 0, v2
    v_sub_f32 v225, 0, v2
    v_sub_f32 v226, 0, v2
    v_sub_f32 v227, 0, v2
    v_sub_f32 v228, 0, v2
    v_sub_f32 v229, 0, v2
    v_sub_f32 v230, 0, v2
    v_sub_f32 v231, 0, v2
    v_sub_f32 v232, 0, v2
    v_sub_f32 v233, 0, v2
    v_sub_f32 v234, 0, v2
    v_sub_f32 v235, 0, v2
    v_sub_f32 v236, 0, v2
    v_sub_f32 v237, 0, v2
    v_sub_f32 v238, 0, v2
    v_sub_f32 v239, 0, v2
    v_sub_f32 v112, v112, v2
    v_sub_f32 v113, v113, v2
    v_sub_f32 v114, v114, v2
    v_sub_f32 v115, v115, v2
    v_sub_f32 v116, v116, v2
    v_sub_f32 v117, v117, v2
    v_sub_f32 v118, v118, v2
    v_sub_f32 v119, v119, v2
    v_sub_f32 v120, v120, v2
    v_sub_f32 v121, v121, v2
    v_sub_f32 v122, v122, v2
    v_sub_f32 v123, v123, v2
    v_sub_f32 v124, v124, v2
    v_sub_f32 v125, v125, v2
    v_sub_f32 v126, v126, v2
    v_sub_f32 v127, v127, v2
    v_sub_f32 v128, v128, v2
    v_sub_f32 v129, v129, v2
    v_sub_f32 v130, v130, v2
    v_sub_f32 v131, v131, v2
    v_sub_f32 v132, v132, v2
    v_sub_f32 v133, v133, v2
    v_sub_f32 v134, v134, v2
    v_sub_f32 v135, v135, v2
    v_sub_f32 v136, v136, v2
    v_sub_f32 v137, v137, v2
    v_sub_f32 v138, v138, v2
    v_sub_f32 v139, v139, v2
    v_sub_f32 v140, v140, v2
    v_sub_f32 v141, v141, v2
    v_sub_f32 v142, v142, v2
    v_sub_f32 v143, v143, v2
    v_exp_f32 v112, v112
    v_exp_f32 v113, v113
    v_exp_f32 v114, v114
    v_mov_b32 v9, v112
    v_exp_f32 v115, v115
    v_mov_b32 v10, v113
    v_exp_f32 v116, v116
    v_add_f32 v9, v9, v114
    v_exp_f32 v117, v117
    v_add_f32 v10, v10, v115
    v_exp_f32 v118, v118
    v_add_f32 v9, v9, v116
    v_exp_f32 v119, v119
    v_add_f32 v10, v10, v117
    v_exp_f32 v120, v120
    v_add_f32 v9, v9, v118
    v_exp_f32 v121, v121
    v_add_f32 v10, v10, v119
    v_exp_f32 v122, v122
    v_add_f32 v9, v9, v120
    v_exp_f32 v123, v123
    v_add_f32 v10, v10, v121
    v_exp_f32 v124, v124
    v_add_f32 v9, v9, v122
    v_exp_f32 v125, v125
    v_add_f32 v10, v10, v123
    v_exp_f32 v126, v126
    v_add_f32 v9, v9, v124
    v_exp_f32 v127, v127
    v_add_f32 v10, v10, v125
    v_exp_f32 v128, v128
    v_add_f32 v9, v9, v126
    v_exp_f32 v129, v129
    v_add_f32 v10, v10, v127
    v_exp_f32 v130, v130
    v_add_f32 v9, v9, v128
    v_exp_f32 v131, v131
    v_add_f32 v10, v10, v129
    v_exp_f32 v132, v132
    v_add_f32 v9, v9, v130
    v_exp_f32 v133, v133
    v_add_f32 v10, v10, v131
    v_exp_f32 v134, v134
    v_add_f32 v9, v9, v132
    v_exp_f32 v135, v135
    v_add_f32 v10, v10, v133
    v_exp_f32 v136, v136
    v_add_f32 v9, v9, v134
    v_exp_f32 v137, v137
    v_add_f32 v10, v10, v135
    v_exp_f32 v138, v138
    v_add_f32 v9, v9, v136
    v_exp_f32 v139, v139
    v_add_f32 v10, v10, v137
    v_exp_f32 v140, v140
    v_add_f32 v9, v9, v138
    v_exp_f32 v141, v141
    v_add_f32 v10, v10, v139
    v_exp_f32 v142, v142
    v_add_f32 v9, v9, v140
    v_exp_f32 v143, v143
    v_add_f32 v10, v10, v141
    v_add_f32 v9, v9, v142
    v_add_f32 v10, v10, v143
    v_add_f32 v9, v9, v10
    v_mul_f32 v3, v3, v4
    v_mul_f32 v48, v4, v48
    v_mul_f32 v49, v4, v49
    v_mul_f32 v50, v4, v50
    v_mul_f32 v51, v4, v51
    v_mul_f32 v52, v4, v52
    v_mul_f32 v53, v4, v53
    v_mul_f32 v54, v4, v54
    v_mul_f32 v55, v4, v55
    v_mul_f32 v56, v4, v56
    v_mul_f32 v57, v4, v57
    v_mul_f32 v58, v4, v58
    v_mul_f32 v59, v4, v59
    v_mul_f32 v60, v4, v60
    v_mul_f32 v61, v4, v61
    v_mul_f32 v62, v4, v62
    v_mul_f32 v63, v4, v63
    v_mul_f32 v64, v4, v64
    v_mul_f32 v65, v4, v65
    v_mul_f32 v66, v4, v66
    v_mul_f32 v67, v4, v67
    v_mul_f32 v68, v4, v68
    v_mul_f32 v69, v4, v69
    v_mul_f32 v70, v4, v70
    v_mul_f32 v71, v4, v71
    v_mul_f32 v72, v4, v72
    v_mul_f32 v73, v4, v73
    v_mul_f32 v74, v4, v74
    v_mul_f32 v75, v4, v75
    v_mul_f32 v76, v4, v76
    v_mul_f32 v77, v4, v77
    v_mul_f32 v78, v4, v78
    v_mul_f32 v79, v4, v79
    v_mul_f32 v80, v4, v80
    v_mul_f32 v81, v4, v81
    v_mul_f32 v82, v4, v82
    v_mul_f32 v83, v4, v83
    v_mul_f32 v84, v4, v84
    v_mul_f32 v85, v4, v85
    v_mul_f32 v86, v4, v86
    v_mul_f32 v87, v4, v87
    v_mul_f32 v88, v4, v88
    v_mul_f32 v89, v4, v89
    v_mul_f32 v90, v4, v90
    v_mul_f32 v91, v4, v91
    v_mul_f32 v92, v4, v92
    v_mul_f32 v93, v4, v93
    v_mul_f32 v94, v4, v94
    v_mul_f32 v95, v4, v95
    v_mul_f32 v96, v4, v96
    v_mul_f32 v97, v4, v97
    v_mul_f32 v98, v4, v98
    v_mul_f32 v99, v4, v99
    v_mul_f32 v100, v4, v100
    v_mul_f32 v101, v4, v101
    v_mul_f32 v102, v4, v102
    v_mul_f32 v103, v4, v103
    v_mul_f32 v104, v4, v104
    v_mul_f32 v105, v4, v105
    v_mul_f32 v106, v4, v106
    v_mul_f32 v107, v4, v107
    v_mul_f32 v108, v4, v108
    v_mul_f32 v109, v4, v109
    v_mul_f32 v110, v4, v110
    v_mul_f32 v111, v4, v111
    s_setpc_b64 s[94:95]
L_wland:
    s_sleep 1
    ds_read_b32 v254, v12
    s_waitcnt lgkmcnt(0)
    v_readfirstlane_b32 s73, v254
    s_nop 0
    s_cmp_ge_u32 s73, s71
    s_cbranch_scc1 L_wland_ok
    s_sub_u32 s72, s72, 1
    s_cbranch_scc0 L_wland
    s_mov_b32 s72, 0
L_wland_ok:
    ds_read_b128 v[160:163], v240 offset:0
    ds_read_b128 v[164:167], v241 offset:0
    ds_read_b128 v[168:171], v242 offset:0
    ds_read_b128 v[172:175], v243 offset:0
    ds_read_b128 v[176:179], v244 offset:0
    ds_read_b128 v[180:183], v245 offset:0
    ds_read_b128 v[184:187], v246 offset:0
    ds_read_b128 v[188:191], v247 offset:0
    s_setpc_b64 s[94:95]
L_special:
    s_cmp_eq_u32 s64, 0
    s_cbranch_scc0 L_sp2
    v_lshlrev_b32 v7, 2, v0
    s_lshl_b32 s73, s3, 8
    buffer_load_dword v11, v7, s[4:7], s73 offen sc1
    buffer_load_dword v255, v7, s[4:7], 0 offen offset:768 sc1
L_sp2:
    s_cmp_eq_u32 s64, 1
    s_cbranch_scc0 L_special_ret
    s_call_b64 s[94:95], L_wchk
    s_branch L_special_ret
L_hburst:
    s_waitcnt vmcnt(0)
    v_mov_b32 v24, s71
    s_mov_b64 exec, 1
    ds_max_u32 v12, v24
    s_mov_b64 exec, -1
    s_call_b64 s[94:95], L_wburst
L_hb_spin:
    ds_read_b128 v[16:19], v12 offset:16
    s_waitcnt lgkmcnt(0)
    v_min3_u32 v16, v16, v17, v18
    s_nop 0
    v_readfirstlane_b32 s73, v16
    s_nop 0
    s_cmp_ge_u32 s73, s65
    s_cbranch_scc1 L_hb_ret
    s_sleep 1
    s_sub_u32 s72, s72, 1
    s_cbranch_scc0 L_hb_spin
    s_mov_b32 s72, 0
L_hb_ret:
    s_setpc_b64 s[92:93]
L_wburst:
    buffer_load_dwordx4 a[0:3], v1, s[36:39], s70 offen offset:0 sc1
    buffer_load_dwordx4 a[4:7], v1, s[36:39], s70 offen offset:1024 sc1
    buffer_load_dwordx4 a[8:11], v1, s[36:39], s70 offen offset:2048 sc1
    buffer_load_dwordx4 a[12:15], v1, s[36:39], s70 offen offset:3072 sc1
    s_add_u32 s70, s70, s74
    buffer_load_dwordx4 a[16:19], v1, s[36:39], s70 offen offset:0 sc1
    buffer_load_dwordx4 a[20:23], v1, s[36:39], s70 offen offset:1024 sc1
    buffer_load_dwordx4 a[24:27], v1, s[36:39], s70 offen offset:2048 sc1
    buffer_load_dwordx4 a[28:31], v1, s[36:39], s70 offen offset:3072 sc1
    s_add_u32 s70, s70, s74
    buffer_load_dwordx4 a[32:35], v1, s[36:39], s70 offen offset:0 sc1
    buffer_load_dwordx4 a[36:39], v1, s[36:39], s70 offen offset:1024 sc1
    buffer_load_dwordx4 a[40:43], v1, s[36:39], s70 offen offset:2048 sc1
    buffer_load_dwordx4 a[44:47], v1, s[36:39], s70 offen offset:3072 sc1
    s_add_u32 s70, s70, s74
    buffer_load_dwordx4 a[48:51], v1, s[36:39], s70 offen offset:0 sc1
    buffer_load_dwordx4 a[52:55], v1, s[36:39], s70 offen offset:1024 sc1
    buffer_load_dwordx4 a[56:59], v1, s[36:39], s70 offen offset:2048 sc1
    buffer_load_dwordx4 a[60:63], v1, s[36:39], s70 offen offset:3072 sc1
    s_add_u32 s70, s70, s74
    buffer_load_dwordx4 a[64:67], v1, s[36:39], s70 offen offset:0 sc1
    buffer_load_dwordx4 a[68:71], v1, s[36:39], s70 offen offset:1024 sc1
    buffer_load_dwordx4 a[72:75], v1, s[36:39], s70 offen offset:2048 sc1
    buffer_load_dwordx4 a[76:79], v1, s[36:39], s70 offen offset:3072 sc1
    s_add_u32 s70, s70, s74
    buffer_load_dwordx4 a[80:83], v1, s[36:39], s70 offen offset:0 sc1
    buffer_load_dwordx4 a[84:87], v1, s[36:39], s70 offen offset:1024 sc1
    buffer_load_dwordx4 a[88:91], v1, s[36:39], s70 offen offset:2048 sc1
    buffer_load_dwordx4 a[92:95], v1, s[36:39], s70 offen offset:3072 sc1
    s_add_u32 s70, s70, s74
    buffer_load_dwordx4 a[96:99], v1, s[36:39], s70 offen offset:0 sc1
    buffer_load_dwordx4 a[100:103], v1, s[36:39], s70 offen offset:1024 sc1
    buffer_load_dwordx4 a[104:107], v1, s[36:39], s70 offen offset:2048 sc1
    buffer_load_dwordx4 a[108:111], v1, s[36:39], s70 offen offset:3072 sc1
    s_add_u32 s70, s70, s74
    buffer_load_dwordx4 a[112:115], v1, s[36:39], s70 offen offset:0 sc1
    buffer_load_dwordx4 a[116:119], v1, s[36:39], s70 offen offset:1024 sc1
    buffer_load_dwordx4 a[120:123], v1, s[36:39], s70 offen offset:2048 sc1
    buffer_load_dwordx4 a[124:127], v1, s[36:39], s70 offen offset:3072 sc1
    s_add_u32 s70, s70, s74
    buffer_load_dwordx4 a[128:131], v1, s[36:39], s70 offen offset:0 sc1
    buffer_load_dwordx4 a[132:135], v1, s[36:39], s70 offen offset:1024 sc1
    buffer_load_dwordx4 a[136:139], v1, s[36:39], s70 offen offset:2048 sc1
    buffer_load_dwordx4 a[140:143], v1, s[36:39], s70 offen offset:3072 sc1
    s_add_u32 s70, s70, s74
    buffer_load_dwordx4 a[144:147], v1, s[36:39], s70 offen offset:0 sc1
    buffer_load_dwordx4 a[148:151], v1, s[36:39], s70 offen offset:1024 sc1
    buffer_load_dwordx4 a[152:155], v1, s[36:39], s70 offen offset:2048 sc1
    buffer_load_dwordx4 a[156:159], v1, s[36:39], s70 offen offset:3072 sc1
    s_add_u32 s70, s70, s74
    buffer_load_dwordx4 a[160:163], v1, s[36:39], s70 offen offset:0 sc1
    buffer_load_dwordx4 a[164:167], v1, s[36:39], s70 offen offset:1024 sc1
    buffer_load_dwordx4 a[168:171], v1, s[36:39], s70 offen offset:2048 sc1
    buffer_load_dwordx4 a[172:175], v1, s[36:39], s70 offen offset:3072 sc1
    s_add_u32 s70, s70, s74
    buffer_load_dwordx4 a[176:179], v1, s[36:39], s70 offen offset:0 sc1
    buffer_load_dwordx4 a[180:183], v1, s[36:39], s70 offen offset:1024 sc1
    buffer_load_dwordx4 a[184:187], v1, s[36:39], s70 offen offset:2048 sc1
    buffer_load_dwordx4 a[188:191], v1, s[36:39], s70 offen offset:3072 sc1
    s_add_u32 s70, s70, s74
    buffer_load_dwordx4 a[192:195], v1, s[36:39], s70 offen offset:0 sc1
    buffer_load_dwordx4 a[196:199], v1, s[36:39], s70 offen offset:1024 sc1
    buffer_load_dwordx4 a[200:203], v1, s[36:39], s70 offen offset:2048 sc1
    buffer_load_dwordx4 a[204:207], v1, s[36:39], s70 offen offset:3072 sc1
    s_add_u32 s70, s70, s74
    buffer_load_dwordx4 a[208:211], v1, s[36:39], s70 offen offset:0 sc1
    buffer_load_dwordx4 a[212:215], v1, s[36:39], s70 offen offset:1024 sc1
    buffer_load_dwordx4 a[216:219], v1, s[36:39], s70 offen offset:2048 sc1
    buffer_load_dwordx4 a[220:223], v1, s[36:39], s70 offen offset:3072 sc1
    s_add_u32 s70, s70, s74
    buffer_load_dwordx4 a[224:227], v1, s[36:39], s70 offen offset:0 sc1
    buffer_load_dwordx4 a[228:231], v1, s[36:39], s70 offen offset:1024 sc1
    buffer_load_dwordx4 a[232:235], v1, s[36:39], s70 offen offset:2048 sc1
    buffer_load_dwordx4 a[236:239], v1, s[36:39], s70 offen offset:3072 sc1
    s_add_u32 s70, s70, s74
    buffer_load_dwordx4 a[240:243], v1, s[36:39], s70 offen offset:0 sc1
    buffer_load_dwordx4 a[244:247], v1, s[36:39], s70 offen offset:1024 sc1
    buffer_load_dwordx4 a[248:251], v1, s[36:39], s70 offen offset:2048 sc1
    buffer_load_dwordx4 a[252:255], v1, s[36:39], s70 offen offset:3072 sc1
    s_add_u32 s70, s70, s74
    s_setpc_b64 s[94:95]
L_wchk:
    s_waitcnt vmcnt(0)
    v_cmp_ne_u32 vcc, s78, v11
    s_cbranch_vccnz L_wchk_retry
    v_cmp_ne_u32 vcc, s78, v255
    s_cbranch_vccnz L_wchk_retry
    s_setpc_b64 s[94:95]
L_wchk_retry:
    s_sub_u32 s72, s72, 50
    s_cbranch_scc1 L_wchk_gu
    s_sleep 8
    v_lshlrev_b32 v7, 2, v0
    s_lshl_b32 s73, s3, 8
    buffer_load_dword v11, v7, s[4:7], s73 offen sc1
    buffer_load_dword v255, v7, s[4:7], 0 offen offset:768 sc1
    s_branch L_wchk
L_wchk_gu:
    s_mov_b32 s72, 0
    s_setpc_b64 s[94:95]
L_side0:
    v_mov_b32 v7, 1
    s_mov_b64 exec, 1
    ds_add_rtn_u32 v8, v12, v7 offset:8
    s_waitcnt lgkmcnt(0)
    v_readfirstlane_b32 s73, v8
    s_nop 0
    s_cmp_lg_u32 s73, 2
    s_cbranch_scc1 L_side0_done
    s_lshl_b32 s73, s2, 2
    v_mov_b32 v8, 0
    v_mov_b32 v7, s78
    buffer_store_dword v7, v8, s[4:7], s73 offen sc1
L_side0_done:
    s_mov_b64 exec, -1
    s_setpc_b64 s[94:95]
L_getep:
    s_waitcnt vmcnt(0)
L_getep0:
    s_memrealtime s[98:99]
    s_waitcnt lgkmcnt(0)
    v_readfirstlane_b32 s78, v3
    s_add_u32 s73, s98, 2
    s_sub_u32 s73, s73, s78
    s_cmp_lt_u32 s73, 3000
    s_cbranch_scc1 L_getep_chk
L_getep_again:
    s_sub_u32 s72, s72, 50
    s_cbranch_scc1 L_getep_gu
    s_sleep 4
    v_mov_b32 v8, 0
    buffer_load_dword v3, v8, s[52:55], 0 offen sc1
    s_branch L_getep
L_getep_chk:
    s_cmp_eq_u32 s78, 0
    s_cbranch_scc1 L_getep_again
    s_setpc_b64 s[94:95]
L_getep_gu:
    s_mov_b32 s72, 0
    s_setpc_b64 s[94:95]
L_helper:
    s_and_b32 s76, s63, 7
    s_lshl_b32 s76, s76, 13
    v_lshlrev_b32 v29, 7, v0
    v_add_u32 v29, s76, v29
    v_min_u32 v29, L_code_end-L_pc_ref, v29
    global_load_dword v15, v29, s[96:97]
    s_lshl_b32 s76, s58, 18
    v_lshl_add_u32 v246, v5, 8, v8
    v_xor_b32 v9, v4, v5
    v_lshlrev_b32 v9, 4, v9
    v_lshl_add_u32 v242, v5, 8, v9
    v_xor_b32 v243, 64, v242
    v_xor_b32 v244, 128, v242
    v_xor_b32 v245, 192, v242
    s_mov_b32 s68, 0
    s_mov_b32 s69, 0
    v_mov_b32 v16, 0
    v_mov_b32 v17, 0
    v_mov_b32 v18, 0
    v_mov_b32 v19, 0x7fffffff
    v_mov_b32 v20, 0
    v_mov_b32 v21, 0
    v_mov_b32 v22, 0
    v_mov_b32 v23, 0
    ds_write_b128 v12, v[20:23]
    ds_write_b128 v12, v[16:19] offset:16
    ds_write_b128 v12, v[16:19] offset:32
    s_waitcnt lgkmcnt(0)
    s_cmp_lg_u32 s2, 0
    s_cbranch_scc1 L_noep
    s_memrealtime s[98:99]
    s_mov_b32 s52, s16
    s_mov_b32 s53, s17
    s_movk_i32 s54, 4
    s_mov_b32 s55, 0x20000
    v_lshlrev_b32 v27, 2, v0
    s_waitcnt lgkmcnt(0)
    s_or_b32 s73, s98, 1
    v_mov_b32 v28, s73
    buffer_store_dword v28, v27, s[52:55], 0 offen sc1
L_noep:
    s_add_u32 s24, s6, s76
    s_addc_u32 s25, s7, 0
    s_mov_b32 s26, 0x40000
    s_mov_b32 s27, 0x20000
    s_add_u32 s28, s8, s76
    s_addc_u32 s29, s9, 0
    s_mov_b32 s30, 0x40000
    s_mov_b32 s31, 0x20000
    s_waitcnt vmcnt(12)
    s_mov_b32 m0, 0
    s_nop 0
    buffer_load_dwordx4 v242, s[24:27], s68 offen offset:0 nt lds
    buffer_load_dwordx4 v243, s[24:27], s68 offen offset:1024 nt lds
    buffer_load_dwordx4 v244, s[24:27], s68 offen offset:2048 nt lds
    buffer_load_dwordx4 v245, s[24:27], s68 offen offset:3072 nt lds
    s_add_u32 s68, s68, s74
    s_waitcnt vmcnt(12)
    s_mov_b32 m0, 4096
    s_nop 0
    buffer_load_dwordx4 v242, s[24:27], s68 offen offset:0 nt lds
    buffer_load_dwordx4 v243, s[24:27], s68 offen offset:1024 nt lds
    buffer_load_dwordx4 v244, s[24:27], s68 offen offset:2048 nt lds
    buffer_load_dwordx4 v245, s[24:27], s68 offen offset:3072 nt lds
    s_add_u32 s68, s68, s74
    s_barrier
    s_and_b32 s59, s62, 1
    s_lshl_b32 s59, s59, 3
    s_and_b32 s73, s63, 7
    s_add_u32 s59, s59, s73
    s_lshr_b32 s60, s62, 1
    s_lshl_b32 s60, s60, 2
    s_lshr_b32 s73, s63, 3
    s_add_u32 s60, s60, s73
    s_lshr_b32 s61, s59, 1
    s_lshl_b32 s73, s3, 16
    s_lshl_b32 s76, s60, 18
    s_add_u32 s73, s73, s76
    s_add_u32 s73, s73, 8388608
    s_add_u32 s36, s18, s73
    s_addc_u32 s37, s19, 0
    s_lshl_b32 s73, s3, 16
    s_sub_u32 s38, 0x40000, s73
    s_mov_b32 s39, 0x20000
    s_lshl_b32 s76, s60, 6
    s_mul_i32 s73, s59, 49152
    s_add_u32 s73, s73, s76
    s_add_u32 s40, s14, s73
    s_addc_u32 s41, s15, 0
    s_sub_u32 s42, 49152, s76
    s_mov_b32 s43, 0x20000
    s_mul_i32 s73, s58, 24576
    s_add_u32 s44, s18, s73
    s_addc_u32 s45, s19, 0
    s_movk_i32 s46, 24576
    s_mov_b32 s47, 0x20000
    s_lshl_b32 s73, s61, 5
    s_lshl_b32 s76, s3, 3
    s_add_u32 s73, s73, s76
    s_mul_i32 s73, s73, 24576
    s_and_b32 s76, s59, 1
    s_mul_i32 s76, s76, 12288
    s_add_u32 s73, s73, s76
    s_add_u32 s48, s18, s73
    s_addc_u32 s49, s19, 0
    s_mov_b32 s50, 184320
    s_mov_b32 s51, 0x20000
    s_mov_b32 s52, s16
    s_mov_b32 s53, s17
    s_movk_i32 s54, 256
    s_mov_b32 s55, 0x20000
    s_add_u32 s4, s18, 12599296
    s_addc_u32 s5, s19, 0
    s_movk_i32 s6, 1024
    s_mov_b32 s7, 0x20000
    s_mov_b32 s72, 200000
    s_mov_b32 s70, 0
    s_and_b32 s77, s63, 7
    s_lshl_b32 s77, s77, 2
    s_lshr_b32 s77, 0x54732160, s77
    s_and_b32 s77, s77, 7
    s_mul_i32 s77, s77, 3
    s_lshr_b32 s77, s77, 1
    s_add_u32 s77, s77, 2
    s_mov_b32 s101, 0
    s_waitcnt vmcnt(12)
    s_mov_b32 m0, 8192
    s_nop 0
    buffer_load_dwordx4 v242, s[24:27], s68 offen offset:0 nt lds
    buffer_load_dwordx4 v243, s[24:27], s68 offen offset:1024 nt lds
    buffer_load_dwordx4 v244, s[24:27], s68 offen offset:2048 nt lds
    buffer_load_dwordx4 v245, s[24:27], s68 offen offset:3072 nt lds
    s_add_u32 s68, s68, s74
    s_waitcnt vmcnt(12)
    s_mov_b32 m0, 12288
    s_nop 0
    buffer_load_dwordx4 v242, s[24:27], s68 offen offset:0 nt lds
    buffer_load_dwordx4 v243, s[24:27], s68 offen offset:1024 nt lds
    buffer_load_dwordx4 v244, s[24:27], s68 offen offset:2048 nt lds
    buffer_load_dwordx4 v245, s[24:27], s68 offen offset:3072 nt lds
    s_add_u32 s68, s68, s74
    s_waitcnt vmcnt(12)
    s_mov_b32 m0, 16384
    s_nop 0
    buffer_load_dwordx4 v242, s[24:27], s68 offen offset:0 nt lds
    buffer_load_dwordx4 v243, s[24:27], s68 offen offset:1024 nt lds
    buffer_load_dwordx4 v244, s[24:27], s68 offen offset:2048 nt lds
    buffer_load_dwordx4 v245, s[24:27], s68 offen offset:3072 nt lds
    s_add_u32 s68, s68, s74
    s_waitcnt vmcnt(12)
    s_mov_b32 m0, 20480
    s_nop 0
    buffer_load_dwordx4 v242, s[24:27], s68 offen offset:0 nt lds
    buffer_load_dwordx4 v243, s[24:27], s68 offen offset:1024 nt lds
    buffer_load_dwordx4 v244, s[24:27], s68 offen offset:2048 nt lds
    buffer_load_dwordx4 v245, s[24:27], s68 offen offset:3072 nt lds
    s_add_u32 s68, s68, s74
    s_waitcnt vmcnt(12)
    s_mov_b32 m0, 24576
    s_nop 0
    buffer_load_dwordx4 v242, s[24:27], s68 offen offset:0 nt lds
    buffer_load_dwordx4 v243, s[24:27], s68 offen offset:1024 nt lds
    buffer_load_dwordx4 v244, s[24:27], s68 offen offset:2048 nt lds
    buffer_load_dwordx4 v245, s[24:27], s68 offen offset:3072 nt lds
    s_add_u32 s68, s68, s74
    s_waitcnt vmcnt(12)
    v_mov_b32 v24, 1
    s_mov_b64 exec, 1
    ds_max_u32 v12, v24
    s_mov_b64 exec, -1
    s_mov_b32 m0, 28672
    s_nop 0
    buffer_load_dwordx4 v242, s[24:27], s68 offen offset:0 nt lds
    buffer_load_dwordx4 v243, s[24:27], s68 offen offset:1024 nt lds
    buffer_load_dwordx4 v244, s[24:27], s68 offen offset:2048 nt lds
    buffer_load_dwordx4 v245, s[24:27], s68 offen offset:3072 nt lds
    s_add_u32 s68, s68, s74
    s_waitcnt vmcnt(12)
    s_mov_b32 m0, 32768
    s_nop 0
    buffer_load_dwordx4 v246, s[28:31], s69 offen offset:0 nt lds
    buffer_load_dwordx4 v246, s[28:31], s69 offen offset:1024 nt lds
    buffer_load_dwordx4 v246, s[28:31], s69 offen offset:2048 nt lds
    buffer_load_dwordx4 v246, s[28:31], s69 offen offset:3072 nt lds
    s_add_u32 s69, s69, s74
    s_waitcnt vmcnt(12)
    s_mov_b32 m0, 36864
    s_nop 0
    buffer_load_dwordx4 v246, s[28:31], s69 offen offset:0 nt lds
    buffer_load_dwordx4 v246, s[28:31], s69 offen offset:1024 nt lds
    buffer_load_dwordx4 v246, s[28:31], s69 offen offset:2048 nt lds
    buffer_load_dwordx4 v246, s[28:31], s69 offen offset:3072 nt lds
    s_add_u32 s69, s69, s74
    s_waitcnt vmcnt(12)
    s_mov_b32 m0, 40960
    s_nop 0
    buffer_load_dwordx4 v246, s[28:31], s69 offen offset:0 nt lds
    buffer_load_dwordx4 v246, s[28:31], s69 offen offset:1024 nt lds
    buffer_load_dwordx4 v246, s[28:31], s69 offen offset:2048 nt lds
    buffer_load_dwordx4 v246, s[28:31], s69 offen offset:3072 nt lds
    s_add_u32 s69, s69, s74
    s_waitcnt vmcnt(12)
    v_mov_b32 v24, 2
    s_mov_b64 exec, 1
    ds_max_u32 v12, v24
    s_mov_b64 exec, -1
    s_mov_b32 m0, 45056
    s_nop 0
    buffer_load_dwordx4 v246, s[28:31], s69 offen offset:0 nt lds
    buffer_load_dwordx4 v246, s[28:31], s69 offen offset:1024 nt lds
    buffer_load_dwordx4 v246, s[28:31], s69 offen offset:2048 nt lds
    buffer_load_dwordx4 v246, s[28:31], s69 offen offset:3072 nt lds
    s_add_u32 s69, s69, s74
    s_waitcnt vmcnt(12)
    buffer_load_dwordx4 a[0:3], v242, s[24:27], s68 offen offset:0 nt
    buffer_load_dwordx4 a[4:7], v243, s[24:27], s68 offen offset:1024 nt
    buffer_load_dwordx4 a[8:11], v244, s[24:27], s68 offen offset:2048 nt
    buffer_load_dwordx4 a[12:15], v245, s[24:27], s68 offen offset:3072 nt
    s_add_u32 s68, s68, s74
    s_waitcnt vmcnt(12)
    buffer_load_dwordx4 a[16:19], v242, s[24:27], s68 offen offset:0 nt
    buffer_load_dwordx4 a[20:23], v243, s[24:27], s68 offen offset:1024 nt
    buffer_load_dwordx4 a[24:27], v244, s[24:27], s68 offen offset:2048 nt
    buffer_load_dwordx4 a[28:31], v245, s[24:27], s68 offen offset:3072 nt
    s_add_u32 s68, s68, s74
    s_waitcnt vmcnt(12)
    buffer_load_dwordx4 a[32:35], v242, s[24:27], s68 offen offset:0 nt
    buffer_load_dwordx4 a[36:39], v243, s[24:27], s68 offen offset:1024 nt
    buffer_load_dwordx4 a[40:43], v244, s[24:27], s68 offen offset:2048 nt
    buffer_load_dwordx4 a[44:47], v245, s[24:27], s68 offen offset:3072 nt
    s_add_u32 s68, s68, s74
    s_waitcnt vmcnt(12)
    v_mov_b32 v24, 3
    s_mov_b64 exec, 1
    ds_max_u32 v12, v24
    s_mov_b64 exec, -1
    buffer_load_dwordx4 a[48:51], v242, s[24:27], s68 offen offset:0 nt
    buffer_load_dwordx4 a[52:55], v243, s[24:27], s68 offen offset:1024 nt
    buffer_load_dwordx4 a[56:59], v244, s[24:27], s68 offen offset:2048 nt
    buffer_load_dwordx4 a[60:63], v245, s[24:27], s68 offen offset:3072 nt
    s_add_u32 s68, s68, s74
    s_waitcnt vmcnt(12)
    buffer_load_dwordx4 a[64:67], v246, s[28:31], s69 offen offset:0 nt
    buffer_load_dwordx4 a[68:71], v246, s[28:31], s69 offen offset:1024 nt
    buffer_load_dwordx4 a[72:75], v246, s[28:31], s69 offen offset:2048 nt
    buffer_load_dwordx4 a[76:79], v246, s[28:31], s69 offen offset:3072 nt
    s_add_u32 s69, s69, s74
    s_waitcnt vmcnt(12)
    buffer_load_dwordx4 a[80:83], v246, s[28:31], s69 offen offset:0 nt
    buffer_load_dwordx4 a[84:87], v246, s[28:31], s69 offen offset:1024 nt
    buffer_load_dwordx4 a[88:91], v246, s[28:31], s69 offen offset:2048 nt
    buffer_load_dwordx4 a[92:95], v246, s[28:31], s69 offen offset:3072 nt
    s_add_u32 s69, s69, s74
    s_waitcnt vmcnt(12)
    buffer_load_dwordx4 a[96:99], v246, s[28:31], s69 offen offset:0 nt
    buffer_load_dwordx4 a[100:103], v246, s[28:31], s69 offen offset:1024 nt
    buffer_load_dwordx4 a[104:107], v246, s[28:31], s69 offen offset:2048 nt
    buffer_load_dwordx4 a[108:111], v246, s[28:31], s69 offen offset:3072 nt
    s_add_u32 s69, s69, s74
    s_waitcnt vmcnt(12)
    buffer_load_dwordx4 a[112:115], v246, s[28:31], s69 offen offset:0 nt
    buffer_load_dwordx4 a[116:119], v246, s[28:31], s69 offen offset:1024 nt
    buffer_load_dwordx4 a[120:123], v246, s[28:31], s69 offen offset:2048 nt
    buffer_load_dwordx4 a[124:127], v246, s[28:31], s69 offen offset:3072 nt
    s_add_u32 s69, s69, s74
    s_waitcnt vmcnt(12)
    buffer_load_dwordx4 a[128:131], v242, s[24:27], s68 offen offset:0 nt
    buffer_load_dwordx4 a[132:135], v243, s[24:27], s68 offen offset:1024 nt
    buffer_load_dwordx4 a[136:139], v244, s[24:27], s68 offen offset:2048 nt
    buffer_load_dwordx4 a[140:143], v245, s[24:27], s68 offen offset:3072 nt
    s_add_u32 s68, s68, s74
    s_waitcnt vmcnt(12)
    buffer_load_dwordx4 a[144:147], v242, s[24:27], s68 offen offset:0 nt
    buffer_load_dwordx4 a[148:151], v243, s[24:27], s68 offen offset:1024 nt
    buffer_load_dwordx4 a[152:155], v244, s[24:27], s68 offen offset:2048 nt
    buffer_load_dwordx4 a[156:159], v245, s[24:27], s68 offen offset:3072 nt
    s_add_u32 s68, s68, s74
    s_waitcnt vmcnt(12)
    buffer_load_dwordx4 a[160:163], v242, s[24:27], s68 offen offset:0 nt
    buffer_load_dwordx4 a[164:167], v243, s[24:27], s68 offen offset:1024 nt
    buffer_load_dwordx4 a[168:171], v244, s[24:27], s68 offen offset:2048 nt
    buffer_load_dwordx4 a[172:175], v245, s[24:27], s68 offen offset:3072 nt
    s_add_u32 s68, s68, s74
    s_waitcnt vmcnt(12)
    buffer_load_dwordx4 a[176:179], v242, s[24:27], s68 offen offset:0 nt
    buffer_load_dwordx4 a[180:183], v243, s[24:27], s68 offen offset:1024 nt
    buffer_load_dwordx4 a[184:187], v244, s[24:27], s68 offen offset:2048 nt
    buffer_load_dwordx4 a[188:191], v245, s[24:27], s68 offen offset:3072 nt
    s_add_u32 s68, s68, s74
    s_waitcnt vmcnt(12)
    buffer_load_dwordx4 a[192:195], v246, s[28:31], s69 offen offset:0 nt
    buffer_load_dwordx4 a[196:199], v246, s[28:31], s69 offen offset:1024 nt
    buffer_load_dwordx4 a[200:203], v246, s[28:31], s69 offen offset:2048 nt
    buffer_load_dwordx4 a[204:207], v246, s[28:31], s69 offen offset:3072 nt
    s_add_u32 s69, s69, s74
    s_waitcnt vmcnt(12)
    buffer_load_dwordx4 a[208:211], v246, s[28:31], s69 offen offset:0 nt
    buffer_load_dwordx4 a[212:215], v246, s[28:31], s69 offen offset:1024 nt
    buffer_load_dwordx4 a[216:219], v246, s[28:31], s69 offen offset:2048 nt
    buffer_load_dwordx4 a[220:223], v246, s[28:31], s69 offen offset:3072 nt
    s_add_u32 s69, s69, s74
    s_waitcnt vmcnt(12)
    buffer_load_dwordx4 a[224:227], v246, s[28:31], s69 offen offset:0 nt
    buffer_load_dwordx4 a[228:231], v246, s[28:31], s69 offen offset:1024 nt
    buffer_load_dwordx4 a[232:235], v246, s[28:31], s69 offen offset:2048 nt
    buffer_load_dwordx4 a[236:239], v246, s[28:31], s69 offen offset:3072 nt
    s_add_u32 s69, s69, s74
    s_waitcnt vmcnt(12)
    buffer_load_dwordx4 a[240:243], v246, s[28:31], s69 offen offset:0 nt
    buffer_load_dwordx4 a[244:247], v246, s[28:31], s69 offen offset:1024 nt
    buffer_load_dwordx4 a[248:251], v246, s[28:31], s69 offen offset:2048 nt
    buffer_load_dwordx4 a[252:255], v246, s[28:31], s69 offen offset:3072 nt
    s_add_u32 s69, s69, s74
    s_waitcnt vmcnt(12)
    buffer_load_dwordx4 v[32:35], v242, s[24:27], s68 offen offset:0 nt
    buffer_load_dwordx4 v[36:39], v243, s[24:27], s68 offen offset:1024 nt
    buffer_load_dwordx4 v[40:43], v244, s[24:27], s68 offen offset:2048 nt
    buffer_load_dwordx4 v[44:47], v245, s[24:27], s68 offen offset:3072 nt
    s_add_u32 s68, s68, s74
    s_waitcnt vmcnt(12)
    buffer_load_dwordx4 v[48:51], v242, s[24:27], s68 offen offset:0 nt
    buffer_load_dwordx4 v[52:55], v243, s[24:27], s68 offen offset:1024 nt
    buffer_load_dwordx4 v[56:59], v244, s[24:27], s68 offen offset:2048 nt
    buffer_load_dwordx4 v[60:63], v245, s[24:27], s68 offen offset:3072 nt
    s_add_u32 s68, s68, s74
    s_waitcnt vmcnt(12)
    buffer_load_dwordx4 v[64:67], v242, s[24:27], s68 offen offset:0 nt
    buffer_load_dwordx4 v[68:71], v243, s[24:27], s68 offen offset:1024 nt
    buffer_load_dwordx4 v[72:75], v244, s[24:27], s68 offen offset:2048 nt
    buffer_load_dwordx4 v[76:79], v245, s[24:27], s68 offen offset:3072 nt
    s_add_u32 s68, s68, s74
    s_waitcnt vmcnt(12)
    buffer_load_dwordx4 v[80:83], v242, s[24:27], s68 offen offset:0 nt
    buffer_load_dwordx4 v[84:87], v243, s[24:27], s68 offen offset:1024 nt
    buffer_load_dwordx4 v[88:91], v244, s[24:27], s68 offen offset:2048 nt
    buffer_load_dwordx4 v[92:95], v245, s[24:27], s68 offen offset:3072 nt
    s_add_u32 s68, s68, s74
    s_waitcnt vmcnt(12)
    buffer_load_dwordx4 v[96:99], v246, s[28:31], s69 offen offset:0 nt
    buffer_load_dwordx4 v[100:103], v246, s[28:31], s69 offen offset:1024 nt
    buffer_load_dwordx4 v[104:107], v246, s[28:31], s69 offen offset:2048 nt
    buffer_load_dwordx4 v[108:111], v246, s[28:31], s69 offen offset:3072 nt
    s_add_u32 s69, s69, s74
    s_waitcnt vmcnt(12)
    buffer_load_dwordx4 v[112:115], v246, s[28:31], s69 offen offset:0 nt
    buffer_load_dwordx4 v[116:119], v246, s[28:31], s69 offen offset:1024 nt
    buffer_load_dwordx4 v[120:123], v246, s[28:31], s69 offen offset:2048 nt
    buffer_load_dwordx4 v[124:127], v246, s[28:31], s69 offen offset:3072 nt
    s_add_u32 s69, s69, s74
    s_waitcnt vmcnt(12)
    buffer_load_dwordx4 v[128:131], v246, s[28:31], s69 offen offset:0 nt
    buffer_load_dwordx4 v[132:135], v246, s[28:31], s69 offen offset:1024 nt
    buffer_load_dwordx4 v[136:139], v246, s[28:31], s69 offen offset:2048 nt
    buffer_load_dwordx4 v[140:143], v246, s[28:31], s69 offen offset:3072 nt
    s_add_u32 s69, s69, s74
    s_waitcnt vmcnt(12)
    buffer_load_dwordx4 v[144:147], v246, s[28:31], s69 offen offset:0 nt
    buffer_load_dwordx4 v[148:151], v246, s[28:31], s69 offen offset:1024 nt
    buffer_load_dwordx4 v[152:155], v246, s[28:31], s69 offen offset:2048 nt
    buffer_load_dwordx4 v[156:159], v246, s[28:31], s69 offen offset:3072 nt
    s_add_u32 s69, s69, s74
    ds_read_b128 v[16:19], v12 offset:16
    s_waitcnt lgkmcnt(0)
    v_min3_u32 v16, v16, v17, v18
    s_nop 0
    v_readfirstlane_b32 s73, v16
    s_nop 0
    s_cmp_ge_u32 s73, 1
    s_cbranch_scc0 L_sfc3_slow
L_sfc3:
    v_add_u32 v26, 49152, v1
    ds_write_b128 v26, a[0:3] offset:0
    ds_write_b128 v26, a[4:7] offset:1024
    ds_write_b128 v26, a[8:11] offset:2048
    ds_write_b128 v26, a[12:15] offset:3072
    ds_write_b128 v26, a[16:19] offset:4096
    ds_write_b128 v26, a[20:23] offset:5120
    ds_write_b128 v26, a[24:27] offset:6144
    ds_write_b128 v26, a[28:31] offset:7168
    s_waitcnt lgkmcnt(4)
    ds_write_b128 v26, a[32:35] offset:8192
    ds_write_b128 v26, a[36:39] offset:9216
    ds_write_b128 v26, a[40:43] offset:10240
    ds_write_b128 v26, a[44:47] offset:11264
    ds_write_b128 v26, a[48:51] offset:12288
    ds_write_b128 v26, a[52:55] offset:13312
    ds_write_b128 v26, a[56:59] offset:14336
    ds_write_b128 v26, a[60:63] offset:15360
    s_waitcnt lgkmcnt(0)
    v_mov_b32 v24, 4
    s_mov_b64 exec, 1
    ds_max_u32 v12, v24
    s_mov_b64 exec, -1
    v_add_u32 v26, 65536, v1
    ds_write_b128 v26, a[64:67] offset:0
    ds_write_b128 v26, a[68:71] offset:1024
    ds_write_b128 v26, a[72:75] offset:2048
    ds_write_b128 v26, a[76:79] offset:3072
    ds_write_b128 v26, a[80:83] offset:4096
    ds_write_b128 v26, a[84:87] offset:5120
    ds_write_b128 v26, a[88:91] offset:6144
    ds_write_b128 v26, a[92:95] offset:7168
    s_waitcnt lgkmcnt(4)
    ds_write_b128 v26, a[96:99] offset:8192
    ds_write_b128 v26, a[100:103] offset:9216
    ds_write_b128 v26, a[104:107] offset:10240
    ds_write_b128 v26, a[108:111] offset:11264
    ds_write_b128 v26, a[112:115] offset:12288
    ds_write_b128 v26, a[116:119] offset:13312
    ds_write_b128 v26, a[120:123] offset:14336
    ds_write_b128 v26, a[124:127] offset:15360
    s_waitcnt lgkmcnt(0)
    v_mov_b32 v24, 5
    s_mov_b64 exec, 1
    ds_max_u32 v12, v24
    s_mov_b64 exec, -1
    s_waitcnt vmcnt(48)
    v_add_u32 v26, 81920, v1
    ds_write_b128 v26, a[128:131] offset:0
    ds_write_b128 v26, a[132:135] offset:1024
    ds_write_b128 v26, a[136:139] offset:2048
    ds_write_b128 v26, a[140:143] offset:3072
    ds_write_b128 v26, a[144:147] offset:4096
    ds_write_b128 v26, a[148:151] offset:5120
    ds_write_b128 v26, a[152:155] offset:6144
    ds_write_b128 v26, a[156:159] offset:7168
    s_waitcnt lgkmcnt(4)
    ds_write_b128 v26, a[160:163] offset:8192
    ds_write_b128 v26, a[164:167] offset:9216
    ds_write_b128 v26, a[168:171] offset:10240
    ds_write_b128 v26, a[172:175] offset:11264
    ds_write_b128 v26, a[176:179] offset:12288
    ds_write_b128 v26, a[180:183] offset:13312
    ds_write_b128 v26, a[184:187] offset:14336
    ds_write_b128 v26, a[188:191] offset:15360
    s_waitcnt lgkmcnt(0)
    v_mov_b32 v24, 6
    s_mov_b64 exec, 1
    ds_max_u32 v12, v24
    s_mov_b64 exec, -1
    s_waitcnt vmcnt(32)
    v_add_u32 v26, 98304, v1
    ds_write_b128 v26, a[192:195] offset:0
    ds_write_b128 v26, a[196:199] offset:1024
    ds_write_b128 v26, a[200:203] offset:2048
    ds_write_b128 v26, a[204:207] offset:3072
    ds_write_b128 v26, a[208:211] offset:4096
    ds_write_b128 v26, a[212:215] offset:5120
    ds_write_b128 v26, a[216:219] offset:6144
    ds_write_b128 v26, a[220:223] offset:7168
    s_waitcnt lgkmcnt(4)
    ds_write_b128 v26, a[224:227] offset:8192
    ds_write_b128 v26, a[228:231] offset:9216
    ds_write_b128 v26, a[232:235] offset:10240
    ds_write_b128 v26, a[236:239] offset:11264
    ds_write_b128 v26, a[240:243] offset:12288
    ds_write_b128 v26, a[244:247] offset:13312
    ds_write_b128 v26, a[248:251] offset:14336
    ds_write_b128 v26, a[252:255] offset:15360
    s_waitcnt lgkmcnt(0)
    v_mov_b32 v24, 7
    s_mov_b64 exec, 1
    ds_max_u32 v12, v24
    s_mov_b64 exec, -1
    s_waitcnt vmcnt(16)
    v_add_u32 v26, 114688, v1
    ds_write_b128 v26, v[32:35] offset:0
    ds_write_b128 v26, v[36:39] offset:1024
    ds_write_b128 v26, v[40:43] offset:2048
    ds_write_b128 v26, v[44:47] offset:3072
    ds_write_b128 v26, v[48:51] offset:4096
    ds_write_b128 v26, v[52:55] offset:5120
    ds_write_b128 v26, v[56:59] offset:6144
    ds_write_b128 v26, v[60:63] offset:7168
    s_waitcnt lgkmcnt(4)
    ds_write_b128 v26, v[64:67] offset:8192
    ds_write_b128 v26, v[68:71] offset:9216
    ds_write_b128 v26, v[72:75] offset:10240
    ds_write_b128 v26, v[76:79] offset:11264
    ds_write_b128 v26, v[80:83] offset:12288
    ds_write_b128 v26, v[84:87] offset:13312
    ds_write_b128 v26, v[88:91] offset:14336
    ds_write_b128 v26, v[92:95] offset:15360
    s_waitcnt lgkmcnt(0)
    v_mov_b32 v24, 8
    s_mov_b64 exec, 1
    ds_max_u32 v12, v24
    s_mov_b64 exec, -1
    s_waitcnt vmcnt(20)
    buffer_load_dwordx4 a[0:3], v242, s[24:27], s68 offen offset:0 nt
    buffer_load_dwordx4 a[4:7], v243, s[24:27], s68 offen offset:1024 nt
    buffer_load_dwordx4 a[8:11], v244, s[24:27], s68 offen offset:2048 nt
    buffer_load_dwordx4 a[12:15], v245, s[24:27], s68 offen offset:3072 nt
    s_add_u32 s68, s68, s74
    s_waitcnt vmcnt(20)
    buffer_load_dwordx4 a[16:19], v242, s[24:27], s68 offen offset:0 nt
    buffer_load_dwordx4 a[20:23], v243, s[24:27], s68 offen offset:1024 nt
    buffer_load_dwordx4 a[24:27], v244, s[24:27], s68 offen offset:2048 nt
    buffer_load_dwordx4 a[28:31], v245, s[24:27], s68 offen offset:3072 nt
    s_add_u32 s68, s68, s74
    s_waitcnt vmcnt(20)
    buffer_load_dwordx4 a[32:35], v242, s[24:27], s68 offen offset:0 nt
    buffer_load_dwordx4 a[36:39], v243, s[24:27], s68 offen offset:1024 nt
    buffer_load_dwordx4 a[40:43], v244, s[24:27], s68 offen offset:2048 nt
    buffer_load_dwordx4 a[44:47], v245, s[24:27], s68 offen offset:3072 nt
    s_add_u32 s68, s68, s74
    s_waitcnt vmcnt(20)
    buffer_load_dwordx4 a[48:51], v242, s[24:27], s68 offen offset:0 nt
    buffer_load_dwordx4 a[52:55], v243, s[24:27], s68 offen offset:1024 nt
    buffer_load_dwordx4 a[56:59], v244, s[24:27], s68 offen offset:2048 nt
    buffer_load_dwordx4 a[60:63], v245, s[24:27], s68 offen offset:3072 nt
    s_add_u32 s68, s68, s74
    s_waitcnt vmcnt(20)
    buffer_load_dwordx4 a[64:67], v246, s[28:31], s69 offen offset:0 nt
    buffer_load_dwordx4 a[68:71], v246, s[28:31], s69 offen offset:1024 nt
    buffer_load_dwordx4 a[72:75], v246, s[28:31], s69 offen offset:2048 nt
    buffer_load_dwordx4 a[76:79], v246, s[28:31], s69 offen offset:3072 nt
    s_add_u32 s69, s69, s74
    s_waitcnt vmcnt(20)
    buffer_load_dwordx4 a[80:83], v246, s[28:31], s69 offen offset:0 nt
    buffer_load_dwordx4 a[84:87], v246, s[28:31], s69 offen offset:1024 nt
    buffer_load_dwordx4 a[88:91], v246, s[28:31], s69 offen offset:2048 nt
    buffer_load_dwordx4 a[92:95], v246, s[28:31], s69 offen offset:3072 nt
    s_add_u32 s69, s69, s74
    s_waitcnt vmcnt(20)
    buffer_load_dwordx4 a[96:99], v246, s[28:31], s69 offen offset:0 nt
    buffer_load_dwordx4 a[100:103], v246, s[28:31], s69 offen offset:1024 nt
    buffer_load_dwordx4 a[104:107], v246, s[28:31], s69 offen offset:2048 nt
    buffer_load_dwordx4 a[108:111], v246, s[28:31], s69 offen offset:3072 nt
    s_add_u32 s69, s69, s74
    s_waitcnt vmcnt(20)
    buffer_load_dwordx4 a[112:115], v246, s[28:31], s69 offen offset:0 nt
    buffer_load_dwordx4 a[116:119], v246, s[28:31], s69 offen offset:1024 nt
    buffer_load_dwordx4 a[120:123], v246, s[28:31], s69 offen offset:2048 nt
    buffer_load_dwordx4 a[124:127], v246, s[28:31], s69 offen offset:3072 nt
    s_add_u32 s69, s69, s74
    s_waitcnt vmcnt(20)
    buffer_load_dwordx4 a[128:131], v242, s[24:27], s68 offen offset:0 nt
    buffer_load_dwordx4 a[132:135], v243, s[24:27], s68 offen offset:1024 nt
    buffer_load_dwordx4 a[136:139], v244, s[24:27], s68 offen offset:2048 nt
    buffer_load_dwordx4 a[140:143], v245, s[24:27], s68 offen offset:3072 nt
    s_add_u32 s68, s68, s74
    s_waitcnt vmcnt(20)
    buffer_load_dwordx4 a[144:147], v242, s[24:27], s68 offen offset:0 nt
    buffer_load_dwordx4 a[148:151], v243, s[24:27], s68 offen offset:1024 nt
    buffer_load_dwordx4 a[152:155], v244, s[24:27], s68 offen offset:2048 nt
    buffer_load_dwordx4 a[156:159], v245, s[24:27], s68 offen offset:3072 nt
    s_add_u32 s68, s68, s74
    s_waitcnt vmcnt(20)
    buffer_load_dwordx4 a[160:163], v242, s[24:27], s68 offen offset:0 nt
    buffer_load_dwordx4 a[164:167], v243, s[24:27], s68 offen offset:1024 nt
    buffer_load_dwordx4 a[168:171], v244, s[24:27], s68 offen offset:2048 nt
    buffer_load_dwordx4 a[172:175], v245, s[24:27], s68 offen offset:3072 nt
    s_add_u32 s68, s68, s74
    s_waitcnt vmcnt(20)
    buffer_load_dwordx4 a[176:179], v242, s[24:27], s68 offen offset:0 nt
    buffer_load_dwordx4 a[180:183], v243, s[24:27], s68 offen offset:1024 nt
    buffer_load_dwordx4 a[184:187], v244, s[24:27], s68 offen offset:2048 nt
    buffer_load_dwordx4 a[188:191], v245, s[24:27], s68 offen offset:3072 nt
    s_add_u32 s68, s68, s74
    ds_read_b128 v[16:19], v12 offset:16
    s_waitcnt lgkmcnt(0)
    v_min3_u32 v16, v16, v17, v18
    s_nop 0
    v_readfirstlane_b32 s73, v16
    s_nop 0
    s_cmp_ge_u32 s73, 2
    s_cbranch_scc0 L_sfc8_slow
L_sfc8:
    s_waitcnt vmcnt(48)
    v_add_u32 v26, 0, v1
    ds_write_b128 v26, v[96:99] offset:0
    ds_write_b128 v26, v[100:103] offset:1024
    ds_write_b128 v26, v[104:107] offset:2048
    ds_write_b128 v26, v[108:111] offset:3072
    ds_write_b128 v26, v[112:115] offset:4096
    ds_write_b128 v26, v[116:119] offset:5120
    ds_write_b128 v26, v[120:123] offset:6144
    ds_write_b128 v26, v[124:127] offset:7168
    s_waitcnt lgkmcnt(4)
    ds_write_b128 v26, v[128:131] offset:8192
    ds_write_b128 v26, v[132:135] offset:9216
    ds_write_b128 v26, v[136:139] offset:10240
    ds_write_b128 v26, v[140:143] offset:11264
    ds_write_b128 v26, v[144:147] offset:12288
    ds_write_b128 v26, v[148:151] offset:13312
    ds_write_b128 v26, v[152:155] offset:14336
    ds_write_b128 v26, v[156:159] offset:15360
    s_waitcnt lgkmcnt(0)
    v_mov_b32 v24, 9
    s_mov_b64 exec, 1
    ds_max_u32 v12, v24
    s_mov_b64 exec, -1
    ds_read_b128 v[16:19], v12 offset:16
    s_waitcnt lgkmcnt(0)
    v_min3_u32 v16, v16, v17, v18
    s_nop 0
    v_readfirstlane_b32 s73, v16
    s_nop 0
    s_cmp_ge_u32 s73, 3
    s_cbranch_scc0 L_sfc9_slow
L_sfc9:
    s_waitcnt vmcnt(32)
    v_add_u32 v26, 16384, v1
    ds_write_b128 v26, a[0:3] offset:0
    ds_write_b128 v26, a[4:7] offset:1024
    ds_write_b128 v26, a[8:11] offset:2048
    ds_write_b128 v26, a[12:15] offset:3072
    ds_write_b128 v26, a[16:19] offset:4096
    ds_write_b128 v26, a[20:23] offset:5120
    ds_write_b128 v26, a[24:27] offset:6144
    ds_write_b128 v26, a[28:31] offset:7168
    s_waitcnt lgkmcnt(4)
    ds_write_b128 v26, a[32:35] offset:8192
    ds_write_b128 v26, a[36:39] offset:9216
    ds_write_b128 v26, a[40:43] offset:10240
    ds_write_b128 v26, a[44:47] offset:11264
    ds_write_b128 v26, a[48:51] offset:12288
    ds_write_b128 v26, a[52:55] offset:13312
    ds_write_b128 v26, a[56:59] offset:14336
    ds_write_b128 v26, a[60:63] offset:15360
    s_waitcnt lgkmcnt(0)
    v_mov_b32 v24, 10
    s_mov_b64 exec, 1
    ds_max_u32 v12, v24
    s_mov_b64 exec, -1
    s_waitcnt vmcnt(16)
    v_add_u32 v26, 32768, v1
    ds_write_b128 v26, a[64:67] offset:0
    ds_write_b128 v26, a[68:71] offset:1024
    ds_write_b128 v26, a[72:75] offset:2048
    ds_write_b128 v26, a[76:79] offset:3072
    ds_write_b128 v26, a[80:83] offset:4096
    ds_write_b128 v26, a[84:87] offset:5120
    ds_write_b128 v26, a[88:91] offset:6144
    ds_write_b128 v26, a[92:95] offset:7168
    s_waitcnt lgkmcnt(4)
    ds_write_b128 v26, a[96:99] offset:8192
    ds_write_b128 v26, a[100:103] offset:9216
    ds_write_b128 v26, a[104:107] offset:10240
    ds_write_b128 v26, a[108:111] offset:11264
    ds_write_b128 v26, a[112:115] offset:12288
    ds_write_b128 v26, a[116:119] offset:13312
    ds_write_b128 v26, a[120:123] offset:14336
    ds_write_b128 v26, a[124:127] offset:15360
    s_waitcnt lgkmcnt(0)
    v_mov_b32 v24, 11
    s_mov_b64 exec, 1
    ds_max_u32 v12, v24
    s_mov_b64 exec, -1
    ds_read_b128 v[16:19], v12 offset:16
    s_waitcnt lgkmcnt(0)
    v_min3_u32 v16, v16, v17, v18
    s_nop 0
    v_readfirstlane_b32 s73, v16
    s_nop 0
    s_cmp_ge_u32 s73, 4
    s_cbranch_scc0 L_sfc11_slow
L_sfc11:
    s_waitcnt vmcnt(0)
    v_add_u32 v26, 49152, v1
    ds_write_b128 v26, a[128:131] offset:0
    ds_write_b128 v26, a[132:135] offset:1024
    ds_write_b128 v26, a[136:139] offset:2048
    ds_write_b128 v26, a[140:143] offset:3072
    ds_write_b128 v26, a[144:147] offset:4096
    ds_write_b128 v26, a[148:151] offset:5120
    ds_write_b128 v26, a[152:155] offset:6144
    ds_write_b128 v26, a[156:159] offset:7168
    s_waitcnt lgkmcnt(4)
    ds_write_b128 v26, a[160:163] offset:8192
    ds_write_b128 v26, a[164:167] offset:9216
    ds_write_b128 v26, a[168:171] offset:10240
    ds_write_b128 v26, a[172:175] offset:11264
    ds_write_b128 v26, a[176:179] offset:12288
    ds_write_b128 v26, a[180:183] offset:13312
    ds_write_b128 v26, a[184:187] offset:14336
    ds_write_b128 v26, a[188:191] offset:15360
    s_waitcnt lgkmcnt(0)
    v_mov_b32 v24, 12
    s_mov_b64 exec, 1
    ds_max_u32 v12, v24
    s_mov_b64 exec, -1
    s_waitcnt vmcnt(20)
    s_mov_b32 m0, 65536
    s_nop 0
    buffer_load_dwordx4 v246, s[28:31], s69 offen offset:0 nt lds
    buffer_load_dwordx4 v246, s[28:31], s69 offen offset:1024 nt lds
    buffer_load_dwordx4 v246, s[28:31], s69 offen offset:2048 nt lds
    buffer_load_dwordx4 v246, s[28:31], s69 offen offset:3072 nt lds
    s_add_u32 s69, s69, s74
    s_waitcnt vmcnt(20)
    s_mov_b32 m0, 69632
    s_nop 0
    buffer_load_dwordx4 v246, s[28:31], s69 offen offset:0 nt lds
    buffer_load_dwordx4 v246, s[28:31], s69 offen offset:1024 nt lds
    buffer_load_dwordx4 v246, s[28:31], s69 offen offset:2048 nt lds
    buffer_load_dwordx4 v246, s[28:31], s69 offen offset:3072 nt lds
    s_add_u32 s69, s69, s74
    s_waitcnt vmcnt(20)
    s_mov_b32 m0, 73728
    s_nop 0
    buffer_load_dwordx4 v246, s[28:31], s69 offen offset:0 nt lds
    buffer_load_dwordx4 v246, s[28:31], s69 offen offset:1024 nt lds
    buffer_load_dwordx4 v246, s[28:31], s69 offen offset:2048 nt lds
    buffer_load_dwordx4 v246, s[28:31], s69 offen offset:3072 nt lds
    s_add_u32 s69, s69, s74
    s_waitcnt vmcnt(20)
    s_mov_b32 m0, 77824
    s_nop 0
    buffer_load_dwordx4 v246, s[28:31], s69 offen offset:0 nt lds
    buffer_load_dwordx4 v246, s[28:31], s69 offen offset:1024 nt lds
    buffer_load_dwordx4 v246, s[28:31], s69 offen offset:2048 nt lds
    buffer_load_dwordx4 v246, s[28:31], s69 offen offset:3072 nt lds
    s_add_u32 s69, s69, s74
    ds_read_b128 v[16:19], v12 offset:16
    s_waitcnt lgkmcnt(0)
    v_min3_u32 v16, v16, v17, v18
    s_nop 0
    v_readfirstlane_b32 s73, v16
    s_nop 0
    s_cmp_ge_u32 s73, 5
    s_cbranch_scc0 L_sfd13_slow
L_sfd13:
    s_add_u32 s76, s77, 2
    s_cmp_lt_u32 s73, s76
    s_cbranch_scc1 L_sfd13_nb
    s_mov_b32 s71, 13
    s_add_u32 s65, s77, 4
    s_min_u32 s65, s65, 8
    s_call_b64 s[92:93], L_hburst
    s_mov_b32 s77, 1000
L_sfd13_nb:
    s_waitcnt vmcnt(20)
    s_mov_b32 m0, 81920
    s_nop 0
    buffer_load_dwordx4 v242, s[24:27], s68 offen offset:0 nt lds
    buffer_load_dwordx4 v243, s[24:27], s68 offen offset:1024 nt lds
    buffer_load_dwordx4 v244, s[24:27], s68 offen offset:2048 nt lds
    buffer_load_dwordx4 v245, s[24:27], s68 offen offset:3072 nt lds
    s_add_u32 s68, s68, s74
    s_waitcnt vmcnt(20)
    s_mov_b32 m0, 86016
    s_nop 0
    buffer_load_dwordx4 v242, s[24:27], s68 offen offset:0 nt lds
    buffer_load_dwordx4 v243, s[24:27], s68 offen offset:1024 nt lds
    buffer_load_dwordx4 v244, s[24:27], s68 offen offset:2048 nt lds
    buffer_load_dwordx4 v245, s[24:27], s68 offen offset:3072 nt lds
    s_add_u32 s68, s68, s74
    s_waitcnt vmcnt(20)
    s_mov_b32 m0, 90112
    s_nop 0
    buffer_load_dwordx4 v242, s[24:27], s68 offen offset:0 nt lds
    buffer_load_dwordx4 v243, s[24:27], s68 offen offset:1024 nt lds
    buffer_load_dwordx4 v244, s[24:27], s68 offen offset:2048 nt lds
    buffer_load_dwordx4 v245, s[24:27], s68 offen offset:3072 nt lds
    s_add_u32 s68, s68, s74
    s_waitcnt vmcnt(20)
    s_mov_b32 m0, 94208
    s_nop 0
    buffer_load_dwordx4 v242, s[24:27], s68 offen offset:0 nt lds
    buffer_load_dwordx4 v243, s[24:27], s68 offen offset:1024 nt lds
    buffer_load_dwordx4 v244, s[24:27], s68 offen offset:2048 nt lds
    buffer_load_dwordx4 v245, s[24:27], s68 offen offset:3072 nt lds
    s_add_u32 s68, s68, s74
    s_waitcnt vmcnt(20)
    s_mov_b32 m0, 98304
    s_nop 0
    buffer_load_dwordx4 v246, s[28:31], s69 offen offset:0 nt lds
    buffer_load_dwordx4 v246, s[28:31], s69 offen offset:1024 nt lds
    buffer_load_dwordx4 v246, s[28:31], s69 offen offset:2048 nt lds
    buffer_load_dwordx4 v246, s[28:31], s69 offen offset:3072 nt lds
    s_add_u32 s69, s69, s74
    s_waitcnt vmcnt(20)
    v_mov_b32 v24, 13
    s_mov_b64 exec, 1
    ds_max_u32 v12, v24
    s_mov_b64 exec, -1
    s_mov_b32 m0, 102400
    s_nop 0
    buffer_load_dwordx4 v246, s[28:31], s69 offen offset:0 nt lds
    buffer_load_dwordx4 v246, s[28:31], s69 offen offset:1024 nt lds
    buffer_load_dwordx4 v246, s[28:31], s69 offen offset:2048 nt lds
    buffer_load_dwordx4 v246, s[28:31], s69 offen offset:3072 nt lds
    s_add_u32 s69, s69, s74
    s_waitcnt vmcnt(20)
    s_mov_b32 m0, 106496
    s_nop 0
    buffer_load_dwordx4 v246, s[28:31], s69 offen offset:0 nt lds
    buffer_load_dwordx4 v246, s[28:31], s69 offen offset:1024 nt lds
    buffer_load_dwordx4 v246, s[28:31], s69 offen offset:2048 nt lds
    buffer_load_dwordx4 v246, s[28:31], s69 offen offset:3072 nt lds
    s_add_u32 s69, s69, s74
    s_waitcnt vmcnt(20)
    s_mov_b32 m0, 110592
    s_nop 0
    buffer_load_dwordx4 v246, s[28:31], s69 offen offset:0 nt lds
    buffer_load_dwordx4 v246, s[28:31], s69 offen offset:1024 nt lds
    buffer_load_dwordx4 v246, s[28:31], s69 offen offset:2048 nt lds
    buffer_load_dwordx4 v246, s[28:31], s69 offen offset:3072 nt lds
    s_add_u32 s69, s69, s74
    ds_read_b128 v[16:19], v12 offset:16
    s_waitcnt lgkmcnt(0)
    v_min3_u32 v16, v16, v17, v18
    s_nop 0
    v_readfirstlane_b32 s73, v16
    s_nop 0
    s_cmp_ge_u32 s73, 6
    s_cbranch_scc0 L_sfd15_slow
L_sfd15:
    s_add_u32 s76, s77, 2
    s_cmp_lt_u32 s73, s76
    s_cbranch_scc1 L_sfd15_nb
    s_mov_b32 s71, 15
    s_add_u32 s65, s77, 4
    s_min_u32 s65, s65, 9
    s_call_b64 s[92:93], L_hburst
    s_mov_b32 s77, 1000
L_sfd15_nb:
    s_waitcnt vmcnt(20)
    s_mov_b32 m0, 114688
    s_nop 0
    buffer_load_dwordx4 v242, s[24:27], s68 offen offset:0 nt lds
    buffer_load_dwordx4 v243, s[24:27], s68 offen offset:1024 nt lds
    buffer_load_dwordx4 v244, s[24:27], s68 offen offset:2048 nt lds
    buffer_load_dwordx4 v245, s[24:27], s68 offen offset:3072 nt lds
    s_add_u32 s68, s68, s74
    s_waitcnt vmcnt(20)
    v_mov_b32 v24, 14
    s_mov_b64 exec, 1
    ds_max_u32 v12, v24
    s_mov_b64 exec, -1
    s_mov_b32 m0, 118784
    s_nop 0
    buffer_load_dwordx4 v242, s[24:27], s68 offen offset:0 nt lds
    buffer_load_dwordx4 v243, s[24:27], s68 offen offset:1024 nt lds
    buffer_load_dwordx4 v244, s[24:27], s68 offen offset:2048 nt lds
    buffer_load_dwordx4 v245, s[24:27], s68 offen offset:3072 nt lds
    s_add_u32 s68, s68, s74
    s_waitcnt vmcnt(20)
    s_mov_b32 m0, 122880
    s_nop 0
    buffer_load_dwordx4 v242, s[24:27], s68 offen offset:0 nt lds
    buffer_load_dwordx4 v243, s[24:27], s68 offen offset:1024 nt lds
    buffer_load_dwordx4 v244, s[24:27], s68 offen offset:2048 nt lds
    buffer_load_dwordx4 v245, s[24:27], s68 offen offset:3072 nt lds
    s_add_u32 s68, s68, s74
    s_waitcnt vmcnt(20)
    s_mov_b32 m0, 126976
    s_nop 0
    buffer_load_dwordx4 v242, s[24:27], s68 offen offset:0 nt lds
    buffer_load_dwordx4 v243, s[24:27], s68 offen offset:1024 nt lds
    buffer_load_dwordx4 v244, s[24:27], s68 offen offset:2048 nt lds
    buffer_load_dwordx4 v245, s[24:27], s68 offen offset:3072 nt lds
    s_add_u32 s68, s68, s74
    s_waitcnt vmcnt(20)
    s_mov_b32 m0, 0
    s_nop 0
    buffer_load_dwordx4 v246, s[28:31], s69 offen offset:0 nt lds
    buffer_load_dwordx4 v246, s[28:31], s69 offen offset:1024 nt lds
    buffer_load_dwordx4 v246, s[28:31], s69 offen offset:2048 nt lds
    buffer_load_dwordx4 v246, s[28:31], s69 offen offset:3072 nt lds
    s_add_u32 s69, s69, s74
    s_waitcnt vmcnt(20)
    v_mov_b32 v24, 15
    s_mov_b64 exec, 1
    ds_max_u32 v12, v24
    s_mov_b64 exec, -1
    s_mov_b32 m0, 4096
    s_nop 0
    buffer_load_dwordx4 v246, s[28:31], s69 offen offset:0 nt lds
    buffer_load_dwordx4 v246, s[28:31], s69 offen offset:1024 nt lds
    buffer_load_dwordx4 v246, s[28:31], s69 offen offset:2048 nt lds
    buffer_load_dwordx4 v246, s[28:31], s69 offen offset:3072 nt lds
    s_add_u32 s69, s69, s74
    s_waitcnt vmcnt(20)
    s_mov_b32 m0, 8192
    s_nop 0
    buffer_load_dwordx4 v246, s[28:31], s69 offen offset:0 nt lds
    buffer_load_dwordx4 v246, s[28:31], s69 offen offset:1024 nt lds
    buffer_load_dwordx4 v246, s[28:31], s69 offen offset:2048 nt lds
    buffer_load_dwordx4 v246, s[28:31], s69 offen offset:3072 nt lds
    s_add_u32 s69, s69, s74
    s_waitcnt vmcnt(20)
    s_mov_b32 m0, 12288
    s_nop 0
    buffer_load_dwordx4 v246, s[28:31], s69 offen offset:0 nt lds
    buffer_load_dwordx4 v246, s[28:31], s69 offen offset:1024 nt lds
    buffer_load_dwordx4 v246, s[28:31], s69 offen offset:2048 nt lds
    buffer_load_dwordx4 v246, s[28:31], s69 offen offset:3072 nt lds
    s_add_u32 s69, s69, s74
    ds_read_b128 v[16:19], v12 offset:16
    s_waitcnt lgkmcnt(0)
    v_min3_u32 v16, v16, v17, v18
    s_nop 0
    v_readfirstlane_b32 s73, v16
    s_nop 0
    s_cmp_ge_u32 s73, 7
    s_cbranch_scc0 L_sfd17_slow
L_sfd17:
    s_add_u32 s76, s77, 2
    s_cmp_lt_u32 s73, s76
    s_cbranch_scc1 L_sfd17_nb
    s_mov_b32 s71, 17
    s_add_u32 s65, s77, 4
    s_min_u32 s65, s65, 10
    s_call_b64 s[92:93], L_hburst
    s_mov_b32 s77, 1000
L_sfd17_nb:
    s_waitcnt vmcnt(20)
    s_mov_b32 m0, 16384
    s_nop 0
    buffer_load_dwordx4 v242, s[24:27], s68 offen offset:0 nt lds
    buffer_load_dwordx4 v243, s[24:27], s68 offen offset:1024 nt lds
    buffer_load_dwordx4 v244, s[24:27], s68 offen offset:2048 nt lds
    buffer_load_dwordx4 v245, s[24:27], s68 offen offset:3072 nt lds
    s_add_u32 s68, s68, s74
    s_waitcnt vmcnt(20)
    v_mov_b32 v24, 16
    s_mov_b64 exec, 1
    ds_max_u32 v12, v24
    s_mov_b64 exec, -1
    s_mov_b32 m0, 20480
    s_nop 0
    buffer_load_dwordx4 v242, s[24:27], s68 offen offset:0 nt lds
    buffer_load_dwordx4 v243, s[24:27], s68 offen offset:1024 nt lds
    buffer_load_dwordx4 v244, s[24:27], s68 offen offset:2048 nt lds
    buffer_load_dwordx4 v245, s[24:27], s68 offen offset:3072 nt lds
    s_add_u32 s68, s68, s74
    s_waitcnt vmcnt(20)
    s_mov_b32 m0, 24576
    s_nop 0
    buffer_load_dwordx4 v242, s[24:27], s68 offen offset:0 nt lds
    buffer_load_dwordx4 v243, s[24:27], s68 offen offset:1024 nt lds
    buffer_load_dwordx4 v244, s[24:27], s68 offen offset:2048 nt lds
    buffer_load_dwordx4 v245, s[24:27], s68 offen offset:3072 nt lds
    s_add_u32 s68, s68, s74
    s_waitcnt vmcnt(20)
    s_mov_b32 m0, 28672
    s_nop 0
    buffer_load_dwordx4 v242, s[24:27], s68 offen offset:0 nt lds
    buffer_load_dwordx4 v243, s[24:27], s68 offen offset:1024 nt lds
    buffer_load_dwordx4 v244, s[24:27], s68 offen offset:2048 nt lds
    buffer_load_dwordx4 v245, s[24:27], s68 offen offset:3072 nt lds
    s_add_u32 s68, s68, s74
    s_waitcnt vmcnt(20)
    s_mov_b32 m0, 32768
    s_nop 0
    buffer_load_dwordx4 v246, s[28:31], s69 offen offset:0 nt lds
    buffer_load_dwordx4 v246, s[28:31], s69 offen offset:1024 nt lds
    buffer_load_dwordx4 v246, s[28:31], s69 offen offset:2048 nt lds
    buffer_load_dwordx4 v246, s[28:31], s69 offen offset:3072 nt lds
    s_add_u32 s69, s69, s74
    s_waitcnt vmcnt(20)
    v_mov_b32 v24, 17
    s_mov_b64 exec, 1
    ds_max_u32 v12, v24
    s_mov_b64 exec, -1
    s_mov_b32 m0, 36864
    s_nop 0
    buffer_load_dwordx4 v246, s[28:31], s69 offen offset:0 nt lds
    buffer_load_dwordx4 v246, s[28:31], s69 offen offset:1024 nt lds
    buffer_load_dwordx4 v246, s[28:31], s69 offen offset:2048 nt lds
    buffer_load_dwordx4 v246, s[28:31], s69 offen offset:3072 nt lds
    s_add_u32 s69, s69, s74
    s_waitcnt vmcnt(20)
    s_mov_b32 m0, 40960
    s_nop 0
    buffer_load_dwordx4 v246, s[28:31], s69 offen offset:0 nt lds
    buffer_load_dwordx4 v246, s[28:31], s69 offen offset:1024 nt lds
    buffer_load_dwordx4 v246, s[28:31], s69 offen offset:2048 nt lds
    buffer_load_dwordx4 v246, s[28:31], s69 offen offset:3072 nt lds
    s_add_u32 s69, s69, s74
    s_waitcnt vmcnt(20)
    s_mov_b32 m0, 45056
    s_nop 0
    buffer_load_dwordx4 v246, s[28:31], s69 offen offset:0 nt lds
    buffer_load_dwordx4 v246, s[28:31], s69 offen offset:1024 nt lds
    buffer_load_dwordx4 v246, s[28:31], s69 offen offset:2048 nt lds
    buffer_load_dwordx4 v246, s[28:31], s69 offen offset:3072 nt lds
    s_add_u32 s69, s69, s74
    ds_read_b128 v[16:19], v12 offset:16
    s_waitcnt lgkmcnt(0)
    v_min3_u32 v16, v16, v17, v18
    s_nop 0
    v_readfirstlane_b32 s73, v16
    s_nop 0
    s_cmp_ge_u32 s73, 8
    s_cbranch_scc0 L_sfd19_slow
L_sfd19:
    s_add_u32 s76, s77, 2
    s_cmp_lt_u32 s73, s76
    s_cbranch_scc1 L_sfd19_nb
    s_mov_b32 s71, 19
    s_add_u32 s65, s77, 4
    s_min_u32 s65, s65, 11
    s_call_b64 s[92:93], L_hburst
    s_mov_b32 s77, 1000
L_sfd19_nb:
    s_waitcnt vmcnt(20)
    s_mov_b32 m0, 49152
    s_nop 0
    buffer_load_dwordx4 v242, s[24:27], s68 offen offset:0 nt lds
    buffer_load_dwordx4 v243, s[24:27], s68 offen offset:1024 nt lds
    buffer_load_dwordx4 v244, s[24:27], s68 offen offset:2048 nt lds
    buffer_load_dwordx4 v245, s[24:27], s68 offen offset:3072 nt lds
    s_add_u32 s68, s68, s74
    s_waitcnt vmcnt(20)
    v_mov_b32 v24, 18
    s_mov_b64 exec, 1
    ds_max_u32 v12, v24
    s_mov_b64 exec, -1
    s_mov_b32 m0, 53248
    s_nop 0
    buffer_load_dwordx4 v242, s[24:27], s68 offen offset:0 nt lds
    buffer_load_dwordx4 v243, s[24:27], s68 offen offset:1024 nt lds
    buffer_load_dwordx4 v244, s[24:27], s68 offen offset:2048 nt lds
    buffer_load_dwordx4 v245, s[24:27], s68 offen offset:3072 nt lds
    s_add_u32 s68, s68, s74
    s_waitcnt vmcnt(20)
    s_mov_b32 m0, 57344
    s_nop 0
    buffer_load_dwordx4 v242, s[24:27], s68 offen offset:0 nt lds
    buffer_load_dwordx4 v243, s[24:27], s68 offen offset:1024 nt lds
    buffer_load_dwordx4 v244, s[24:27], s68 offen offset:2048 nt lds
    buffer_load_dwordx4 v245, s[24:27], s68 offen offset:3072 nt lds
    s_add_u32 s68, s68, s74
    s_waitcnt vmcnt(20)
    s_mov_b32 m0, 61440
    s_nop 0
    buffer_load_dwordx4 v242, s[24:27], s68 offen offset:0 nt lds
    buffer_load_dwordx4 v243, s[24:27], s68 offen offset:1024 nt lds
    buffer_load_dwordx4 v244, s[24:27], s68 offen offset:2048 nt lds
    buffer_load_dwordx4 v245, s[24:27], s68 offen offset:3072 nt lds
    s_add_u32 s68, s68, s74
    s_waitcnt vmcnt(20)
    s_mov_b32 m0, 65536
    s_nop 0
    buffer_load_dwordx4 v246, s[28:31], s69 offen offset:0 nt lds
    buffer_load_dwordx4 v246, s[28:31], s69 offen offset:1024 nt lds
    buffer_load_dwordx4 v246, s[28:31], s69 offen offset:2048 nt lds
    buffer_load_dwordx4 v246, s[28:31], s69 offen offset:3072 nt lds
    s_add_u32 s69, s69, s74
    s_waitcnt vmcnt(20)
    v_mov_b32 v24, 19
    s_mov_b64 exec, 1
    ds_max_u32 v12, v24
    s_mov_b64 exec, -1
    s_mov_b32 m0, 69632
    s_nop 0
    buffer_load_dwordx4 v246, s[28:31], s69 offen offset:0 nt lds
    buffer_load_dwordx4 v246, s[28:31], s69 offen offset:1024 nt lds
    buffer_load_dwordx4 v246, s[28:31], s69 offen offset:2048 nt lds
    buffer_load_dwordx4 v246, s[28:31], s69 offen offset:3072 nt lds
    s_add_u32 s69, s69, s74
    s_waitcnt vmcnt(20)
    s_mov_b32 m0, 73728
    s_nop 0
    buffer_load_dwordx4 v246, s[28:31], s69 offen offset:0 nt lds
    buffer_load_dwordx4 v246, s[28:31], s69 offen offset:1024 nt lds
    buffer_load_dwordx4 v246, s[28:31], s69 offen offset:2048 nt lds
    buffer_load_dwordx4 v246, s[28:31], s69 offen offset:3072 nt lds
    s_add_u32 s69, s69, s74
    s_waitcnt vmcnt(20)
    s_mov_b32 m0, 77824
    s_nop 0
    buffer_load_dwordx4 v246, s[28:31], s69 offen offset:0 nt lds
    buffer_load_dwordx4 v246, s[28:31], s69 offen offset:1024 nt lds
    buffer_load_dwordx4 v246, s[28:31], s69 offen offset:2048 nt lds
    buffer_load_dwordx4 v246, s[28:31], s69 offen offset:3072 nt lds
    s_add_u32 s69, s69, s74
    ds_read_b128 v[16:19], v12 offset:16
    s_waitcnt lgkmcnt(0)
    v_min3_u32 v16, v16, v17, v18
    s_nop 0
    v_readfirstlane_b32 s73, v16
    s_nop 0
    s_cmp_ge_u32 s73, 9
    s_cbranch_scc0 L_sfd21_slow
L_sfd21:
    s_add_u32 s76, s77, 2
    s_cmp_lt_u32 s73, s76
    s_cbranch_scc1 L_sfd21_nb
    s_mov_b32 s71, 21
    s_add_u32 s65, s77, 4
    s_min_u32 s65, s65, 12
    s_call_b64 s[92:93], L_hburst
    s_mov_b32 s77, 1000
L_sfd21_nb:
    s_waitcnt vmcnt(20)
    s_mov_b32 m0, 81920
    s_nop 0
    buffer_load_dwordx4 v242, s[24:27], s68 offen offset:0 nt lds
    buffer_load_dwordx4 v243, s[24:27], s68 offen offset:1024 nt lds
    buffer_load_dwordx4 v244, s[24:27], s68 offen offset:2048 nt lds
    buffer_load_dwordx4 v245, s[24:27], s68 offen offset:3072 nt lds
    s_add_u32 s68, s68, s74
    s_waitcnt vmcnt(20)
    v_mov_b32 v24, 20
    s_mov_b64 exec, 1
    ds_max_u32 v12, v24
    s_mov_b64 exec, -1
    s_mov_b32 m0, 86016
    s_nop 0
    buffer_load_dwordx4 v242, s[24:27], s68 offen offset:0 nt lds
    buffer_load_dwordx4 v243, s[24:27], s68 offen offset:1024 nt lds
    buffer_load_dwordx4 v244, s[24:27], s68 offen offset:2048 nt lds
    buffer_load_dwordx4 v245, s[24:27], s68 offen offset:3072 nt lds
    s_add_u32 s68, s68, s74
    s_waitcnt vmcnt(20)
    s_mov_b32 m0, 90112
    s_nop 0
    buffer_load_dwordx4 v242, s[24:27], s68 offen offset:0 nt lds
    buffer_load_dwordx4 v243, s[24:27], s68 offen offset:1024 nt lds
    buffer_load_dwordx4 v244, s[24:27], s68 offen offset:2048 nt lds
    buffer_load_dwordx4 v245, s[24:27], s68 offen offset:3072 nt lds
    s_add_u32 s68, s68, s74
    s_waitcnt vmcnt(20)
    s_mov_b32 m0, 94208
    s_nop 0
    buffer_load_dwordx4 v242, s[24:27], s68 offen offset:0 nt lds
    buffer_load_dwordx4 v243, s[24:27], s68 offen offset:1024 nt lds
    buffer_load_dwordx4 v244, s[24:27], s68 offen offset:2048 nt lds
    buffer_load_dwordx4 v245, s[24:27], s68 offen offset:3072 nt lds
    s_add_u32 s68, s68, s74
    s_waitcnt vmcnt(20)
    s_mov_b32 m0, 98304
    s_nop 0
    buffer_load_dwordx4 v246, s[28:31], s69 offen offset:0 nt lds
    buffer_load_dwordx4 v246, s[28:31], s69 offen offset:1024 nt lds
    buffer_load_dwordx4 v246, s[28:31], s69 offen offset:2048 nt lds
    buffer_load_dwordx4 v246, s[28:31], s69 offen offset:3072 nt lds
    s_add_u32 s69, s69, s74
    s_waitcnt vmcnt(20)
    v_mov_b32 v24, 21
    s_mov_b64 exec, 1
    ds_max_u32 v12, v24
    s_mov_b64 exec, -1
    s_mov_b32 m0, 102400
    s_nop 0
    buffer_load_dwordx4 v246, s[28:31], s69 offen offset:0 nt lds
    buffer_load_dwordx4 v246, s[28:31], s69 offen offset:1024 nt lds
    buffer_load_dwordx4 v246, s[28:31], s69 offen offset:2048 nt lds
    buffer_load_dwordx4 v246, s[28:31], s69 offen offset:3072 nt lds
    s_add_u32 s69, s69, s74
    s_waitcnt vmcnt(20)
    s_mov_b32 m0, 106496
    s_nop 0
    buffer_load_dwordx4 v246, s[28:31], s69 offen offset:0 nt lds
    buffer_load_dwordx4 v246, s[28:31], s69 offen offset:1024 nt lds
    buffer_load_dwordx4 v246, s[28:31], s69 offen offset:2048 nt lds
    buffer_load_dwordx4 v246, s[28:31], s69 offen offset:3072 nt lds
    s_add_u32 s69, s69, s74
    s_waitcnt vmcnt(20)
    s_mov_b32 m0, 110592
    s_nop 0
    buffer_load_dwordx4 v246, s[28:31], s69 offen offset:0 nt lds
    buffer_load_dwordx4 v246, s[28:31], s69 offen offset:1024 nt lds
    buffer_load_dwordx4 v246, s[28:31], s69 offen offset:2048 nt lds
    buffer_load_dwordx4 v246, s[28:31], s69 offen offset:3072 nt lds
    s_add_u32 s69, s69, s74
    ds_read_b128 v[16:19], v12 offset:16
    s_waitcnt lgkmcnt(0)
    v_min3_u32 v16, v16, v17, v18
    s_nop 0
    v_readfirstlane_b32 s73, v16
    s_nop 0
    s_cmp_ge_u32 s73, 10
    s_cbranch_scc0 L_sfd23_slow
L_sfd23:
    s_add_u32 s76, s77, 2
    s_cmp_lt_u32 s73, s76
    s_cbranch_scc1 L_sfd23_nb
    s_mov_b32 s71, 23
    s_add_u32 s65, s77, 4
    s_min_u32 s65, s65, 13
    s_call_b64 s[92:93], L_hburst
    s_mov_b32 s77, 1000
L_sfd23_nb:
    s_waitcnt vmcnt(20)
    s_mov_b32 m0, 114688
    s_nop 0
    buffer_load_dwordx4 v242, s[24:27], s68 offen offset:0 nt lds
    buffer_load_dwordx4 v243, s[24:27], s68 offen offset:1024 nt lds
    buffer_load_dwordx4 v244, s[24:27], s68 offen offset:2048 nt lds
    buffer_load_dwordx4 v245, s[24:27], s68 offen offset:3072 nt lds
    s_add_u32 s68, s68, s74
    s_waitcnt vmcnt(20)
    v_mov_b32 v24, 22
    s_mov_b64 exec, 1
    ds_max_u32 v12, v24
    s_mov_b64 exec, -1
    s_mov_b32 m0, 118784
    s_nop 0
    buffer_load_dwordx4 v242, s[24:27], s68 offen offset:0 nt lds
    buffer_load_dwordx4 v243, s[24:27], s68 offen offset:1024 nt lds
    buffer_load_dwordx4 v244, s[24:27], s68 offen offset:2048 nt lds
    buffer_load_dwordx4 v245, s[24:27], s68 offen offset:3072 nt lds
    s_add_u32 s68, s68, s74
    s_waitcnt vmcnt(20)
    s_mov_b32 m0, 122880
    s_nop 0
    buffer_load_dwordx4 v242, s[24:27], s68 offen offset:0 nt lds
    buffer_load_dwordx4 v243, s[24:27], s68 offen offset:1024 nt lds
    buffer_load_dwordx4 v244, s[24:27], s68 offen offset:2048 nt lds
    buffer_load_dwordx4 v245, s[24:27], s68 offen offset:3072 nt lds
    s_add_u32 s68, s68, s74
    s_waitcnt vmcnt(20)
    s_mov_b32 m0, 126976
    s_nop 0
    buffer_load_dwordx4 v242, s[24:27], s68 offen offset:0 nt lds
    buffer_load_dwordx4 v243, s[24:27], s68 offen offset:1024 nt lds
    buffer_load_dwordx4 v244, s[24:27], s68 offen offset:2048 nt lds
    buffer_load_dwordx4 v245, s[24:27], s68 offen offset:3072 nt lds
    s_add_u32 s68, s68, s74
    s_waitcnt vmcnt(20)
    s_mov_b32 m0, 0
    s_nop 0
    buffer_load_dwordx4 v246, s[28:31], s69 offen offset:0 nt lds
    buffer_load_dwordx4 v246, s[28:31], s69 offen offset:1024 nt lds
    buffer_load_dwordx4 v246, s[28:31], s69 offen offset:2048 nt lds
    buffer_load_dwordx4 v246, s[28:31], s69 offen offset:3072 nt lds
    s_add_u32 s69, s69, s74
    s_waitcnt vmcnt(20)
    v_mov_b32 v24, 23
    s_mov_b64 exec, 1
    ds_max_u32 v12, v24
    s_mov_b64 exec, -1
    s_mov_b32 m0, 4096
    s_nop 0
    buffer_load_dwordx4 v246, s[28:31], s69 offen offset:0 nt lds
    buffer_load_dwordx4 v246, s[28:31], s69 offen offset:1024 nt lds
    buffer_load_dwordx4 v246, s[28:31], s69 offen offset:2048 nt lds
    buffer_load_dwordx4 v246, s[28:31], s69 offen offset:3072 nt lds
    s_add_u32 s69, s69, s74
    s_waitcnt vmcnt(20)
    s_mov_b32 m0, 8192
    s_nop 0
    buffer_load_dwordx4 v246, s[28:31], s69 offen offset:0 nt lds
    buffer_load_dwordx4 v246, s[28:31], s69 offen offset:1024 nt lds
    buffer_load_dwordx4 v246, s[28:31], s69 offen offset:2048 nt lds
    buffer_load_dwordx4 v246, s[28:31], s69 offen offset:3072 nt lds
    s_add_u32 s69, s69, s74
    s_waitcnt vmcnt(20)
    s_mov_b32 m0, 12288
    s_nop 0
    buffer_load_dwordx4 v246, s[28:31], s69 offen offset:0 nt lds
    buffer_load_dwordx4 v246, s[28:31], s69 offen offset:1024 nt lds
    buffer_load_dwordx4 v246, s[28:31], s69 offen offset:2048 nt lds
    buffer_load_dwordx4 v246, s[28:31], s69 offen offset:3072 nt lds
    s_add_u32 s69, s69, s74
    ds_read_b128 v[16:19], v12 offset:16
    s_waitcnt lgkmcnt(0)
    v_min3_u32 v16, v16, v17, v18
    s_nop 0
    v_readfirstlane_b32 s73, v16
    s_nop 0
    s_cmp_ge_u32 s73, 11
    s_cbranch_scc0 L_sfd25_slow
L_sfd25:
    s_add_u32 s76, s77, 2
    s_cmp_lt_u32 s73, s76
    s_cbranch_scc1 L_sfd25_nb
    s_mov_b32 s71, 25
    s_add_u32 s65, s77, 4
    s_min_u32 s65, s65, 14
    s_call_b64 s[92:93], L_hburst
    s_mov_b32 s77, 1000
L_sfd25_nb:
    s_waitcnt vmcnt(20)
    s_mov_b32 m0, 16384
    s_nop 0
    buffer_load_dwordx4 v242, s[24:27], s68 offen offset:0 nt lds
    buffer_load_dwordx4 v243, s[24:27], s68 offen offset:1024 nt lds
    buffer_load_dwordx4 v244, s[24:27], s68 offen offset:2048 nt lds
    buffer_load_dwordx4 v245, s[24:27], s68 offen offset:3072 nt lds
    s_add_u32 s68, s68, s74
    s_waitcnt vmcnt(20)
    v_mov_b32 v24, 24
    s_mov_b64 exec, 1
    ds_max_u32 v12, v24
    s_mov_b64 exec, -1
    s_mov_b32 m0, 20480
    s_nop 0
    buffer_load_dwordx4 v242, s[24:27], s68 offen offset:0 nt lds
    buffer_load_dwordx4 v243, s[24:27], s68 offen offset:1024 nt lds
    buffer_load_dwordx4 v244, s[24:27], s68 offen offset:2048 nt lds
    buffer_load_dwordx4 v245, s[24:27], s68 offen offset:3072 nt lds
    s_add_u32 s68, s68, s74
    s_waitcnt vmcnt(20)
    s_mov_b32 m0, 24576
    s_nop 0
    buffer_load_dwordx4 v242, s[24:27], s68 offen offset:0 nt lds
    buffer_load_dwordx4 v243, s[24:27], s68 offen offset:1024 nt lds
    buffer_load_dwordx4 v244, s[24:27], s68 offen offset:2048 nt lds
    buffer_load_dwordx4 v245, s[24:27], s68 offen offset:3072 nt lds
    s_add_u32 s68, s68, s74
    s_waitcnt vmcnt(20)
    s_mov_b32 m0, 28672
    s_nop 0
    buffer_load_dwordx4 v242, s[24:27], s68 offen offset:0 nt lds
    buffer_load_dwordx4 v243, s[24:27], s68 offen offset:1024 nt lds
    buffer_load_dwordx4 v244, s[24:27], s68 offen offset:2048 nt lds
    buffer_load_dwordx4 v245, s[24:27], s68 offen offset:3072 nt lds
    s_add_u32 s68, s68, s74
    s_waitcnt vmcnt(20)
    s_mov_b32 m0, 32768
    s_nop 0
    buffer_load_dwordx4 v246, s[28:31], s69 offen offset:0 nt lds
    buffer_load_dwordx4 v246, s[28:31], s69 offen offset:1024 nt lds
    buffer_load_dwordx4 v246, s[28:31], s69 offen offset:2048 nt lds
    buffer_load_dwordx4 v246, s[28:31], s69 offen offset:3072 nt lds
    s_add_u32 s69, s69, s74
    s_waitcnt vmcnt(20)
    v_mov_b32 v24, 25
    s_mov_b64 exec, 1
    ds_max_u32 v12, v24
    s_mov_b64 exec, -1
    s_mov_b32 m0, 36864
    s_nop 0
    buffer_load_dwordx4 v246, s[28:31], s69 offen offset:0 nt lds
    buffer_load_dwordx4 v246, s[28:31], s69 offen offset:1024 nt lds
    buffer_load_dwordx4 v246, s[28:31], s69 offen offset:2048 nt lds
    buffer_load_dwordx4 v246, s[28:31], s69 offen offset:3072 nt lds
    s_add_u32 s69, s69, s74
    s_waitcnt vmcnt(20)
    s_mov_b32 m0, 40960
    s_nop 0
    buffer_load_dwordx4 v246, s[28:31], s69 offen offset:0 nt lds
    buffer_load_dwordx4 v246, s[28:31], s69 offen offset:1024 nt lds
    buffer_load_dwordx4 v246, s[28:31], s69 offen offset:2048 nt lds
    buffer_load_dwordx4 v246, s[28:31], s69 offen offset:3072 nt lds
    s_add_u32 s69, s69, s74
    s_waitcnt vmcnt(20)
    s_mov_b32 m0, 45056
    s_nop 0
    buffer_load_dwordx4 v246, s[28:31], s69 offen offset:0 nt lds
    buffer_load_dwordx4 v246, s[28:31], s69 offen offset:1024 nt lds
    buffer_load_dwordx4 v246, s[28:31], s69 offen offset:2048 nt lds
    buffer_load_dwordx4 v246, s[28:31], s69 offen offset:3072 nt lds
    s_add_u32 s69, s69, s74
    ds_read_b128 v[16:19], v12 offset:16
    s_waitcnt lgkmcnt(0)
    v_min3_u32 v16, v16, v17, v18
    s_nop 0
    v_readfirstlane_b32 s73, v16
    s_nop 0
    s_cmp_ge_u32 s73, 12
    s_cbranch_scc0 L_sfd27_slow
L_sfd27:
    s_add_u32 s76, s77, 2
    s_cmp_lt_u32 s73, s76
    s_cbranch_scc1 L_sfd27_nb
    s_mov_b32 s71, 27
    s_add_u32 s65, s77, 4
    s_min_u32 s65, s65, 15
    s_call_b64 s[92:93], L_hburst
    s_mov_b32 s77, 1000
L_sfd27_nb:
    s_waitcnt vmcnt(20)
    s_mov_b32 m0, 49152
    s_nop 0
    buffer_load_dwordx4 v242, s[24:27], s68 offen offset:0 nt lds
    buffer_load_dwordx4 v243, s[24:27], s68 offen offset:1024 nt lds
    buffer_load_dwordx4 v244, s[24:27], s68 offen offset:2048 nt lds
    buffer_load_dwordx4 v245, s[24:27], s68 offen offset:3072 nt lds
    s_add_u32 s68, s68, s74
    s_waitcnt vmcnt(20)
    v_mov_b32 v24, 26
    s_mov_b64 exec, 1
    ds_max_u32 v12, v24
    s_mov_b64 exec, -1
    s_mov_b32 m0, 53248
    s_nop 0
    buffer_load_dwordx4 v242, s[24:27], s68 offen offset:0 nt lds
    buffer_load_dwordx4 v243, s[24:27], s68 offen offset:1024 nt lds
    buffer_load_dwordx4 v244, s[24:27], s68 offen offset:2048 nt lds
    buffer_load_dwordx4 v245, s[24:27], s68 offen offset:3072 nt lds
    s_add_u32 s68, s68, s74
    s_waitcnt vmcnt(20)
    s_mov_b32 m0, 57344
    s_nop 0
    buffer_load_dwordx4 v242, s[24:27], s68 offen offset:0 nt lds
    buffer_load_dwordx4 v243, s[24:27], s68 offen offset:1024 nt lds
    buffer_load_dwordx4 v244, s[24:27], s68 offen offset:2048 nt lds
    buffer_load_dwordx4 v245, s[24:27], s68 offen offset:3072 nt lds
    s_add_u32 s68, s68, s74
    s_waitcnt vmcnt(20)
    s_mov_b32 m0, 61440
    s_nop 0
    buffer_load_dwordx4 v242, s[24:27], s68 offen offset:0 nt lds
    buffer_load_dwordx4 v243, s[24:27], s68 offen offset:1024 nt lds
    buffer_load_dwordx4 v244, s[24:27], s68 offen offset:2048 nt lds
    buffer_load_dwordx4 v245, s[24:27], s68 offen offset:3072 nt lds
    s_add_u32 s68, s68, s74
    s_waitcnt vmcnt(20)
    s_mov_b32 m0, 65536
    s_nop 0
    buffer_load_dwordx4 v246, s[28:31], s69 offen offset:0 nt lds
    buffer_load_dwordx4 v246, s[28:31], s69 offen offset:1024 nt lds
    buffer_load_dwordx4 v246, s[28:31], s69 offen offset:2048 nt lds
    buffer_load_dwordx4 v246, s[28:31], s69 offen offset:3072 nt lds
    s_add_u32 s69, s69, s74
    s_waitcnt vmcnt(20)
    v_mov_b32 v24, 27
    s_mov_b64 exec, 1
    ds_max_u32 v12, v24
    s_mov_b64 exec, -1
    s_mov_b32 m0, 69632
    s_nop 0
    buffer_load_dwordx4 v246, s[28:31], s69 offen offset:0 nt lds
    buffer_load_dwordx4 v246, s[28:31], s69 offen offset:1024 nt lds
    buffer_load_dwordx4 v246, s[28:31], s69 offen offset:2048 nt lds
    buffer_load_dwordx4 v246, s[28:31], s69 offen offset:3072 nt lds
    s_add_u32 s69, s69, s74
    s_waitcnt vmcnt(20)
    s_mov_b32 m0, 73728
    s_nop 0
    buffer_load_dwordx4 v246, s[28:31], s69 offen offset:0 nt lds
    buffer_load_dwordx4 v246, s[28:31], s69 offen offset:1024 nt lds
    buffer_load_dwordx4 v246, s[28:31], s69 offen offset:2048 nt lds
    buffer_load_dwordx4 v246, s[28:31], s69 offen offset:3072 nt lds
    s_add_u32 s69, s69, s74
    s_waitcnt vmcnt(20)
    s_mov_b32 m0, 77824
    s_nop 0
    buffer_load_dwordx4 v246, s[28:31], s69 offen offset:0 nt lds
    buffer_load_dwordx4 v246, s[28:31], s69 offen offset:1024 nt lds
    buffer_load_dwordx4 v246, s[28:31], s69 offen offset:2048 nt lds
    buffer_load_dwordx4 v246, s[28:31], s69 offen offset:3072 nt lds
    s_add_u32 s69, s69, s74
    ds_read_b128 v[16:19], v12 offset:16
    s_waitcnt lgkmcnt(0)
    v_min3_u32 v16, v16, v17, v18
    s_nop 0
    v_readfirstlane_b32 s73, v16
    s_nop 0
    s_cmp_ge_u32 s73, 13
    s_cbranch_scc0 L_sfd29_slow
L_sfd29:
    s_add_u32 s76, s77, 2
    s_cmp_lt_u32 s73, s76
    s_cbranch_scc1 L_sfd29_nb
    s_mov_b32 s71, 29
    s_add_u32 s65, s77, 4
    s_min_u32 s65, s65, 16
    s_call_b64 s[92:93], L_hburst
    s_mov_b32 s77, 1000
L_sfd29_nb:
    s_waitcnt vmcnt(20)
    s_mov_b32 m0, 81920
    s_nop 0
    buffer_load_dwordx4 v242, s[24:27], s68 offen offset:0 nt lds
    buffer_load_dwordx4 v243, s[24:27], s68 offen offset:1024 nt lds
    buffer_load_dwordx4 v244, s[24:27], s68 offen offset:2048 nt lds
    buffer_load_dwordx4 v245, s[24:27], s68 offen offset:3072 nt lds
    s_add_u32 s68, s68, s74
    s_waitcnt vmcnt(20)
    v_mov_b32 v24, 28
    s_mov_b64 exec, 1
    ds_max_u32 v12, v24
    s_mov_b64 exec, -1
    s_mov_b32 m0, 86016
    s_nop 0
    buffer_load_dwordx4 v242, s[24:27], s68 offen offset:0 nt lds
    buffer_load_dwordx4 v243, s[24:27], s68 offen offset:1024 nt lds
    buffer_load_dwordx4 v244, s[24:27], s68 offen offset:2048 nt lds
    buffer_load_dwordx4 v245, s[24:27], s68 offen offset:3072 nt lds
    s_add_u32 s68, s68, s74
    s_waitcnt vmcnt(20)
    s_mov_b32 m0, 90112
    s_nop 0
    buffer_load_dwordx4 v242, s[24:27], s68 offen offset:0 nt lds
    buffer_load_dwordx4 v243, s[24:27], s68 offen offset:1024 nt lds
    buffer_load_dwordx4 v244, s[24:27], s68 offen offset:2048 nt lds
    buffer_load_dwordx4 v245, s[24:27], s68 offen offset:3072 nt lds
    s_add_u32 s68, s68, s74
    s_waitcnt vmcnt(20)
    s_mov_b32 m0, 94208
    s_nop 0
    buffer_load_dwordx4 v242, s[24:27], s68 offen offset:0 nt lds
    buffer_load_dwordx4 v243, s[24:27], s68 offen offset:1024 nt lds
    buffer_load_dwordx4 v244, s[24:27], s68 offen offset:2048 nt lds
    buffer_load_dwordx4 v245, s[24:27], s68 offen offset:3072 nt lds
    s_add_u32 s68, s68, s74
    s_waitcnt vmcnt(20)
    s_mov_b32 m0, 98304
    s_nop 0
    buffer_load_dwordx4 v246, s[28:31], s69 offen offset:0 nt lds
    buffer_load_dwordx4 v246, s[28:31], s69 offen offset:1024 nt lds
    buffer_load_dwordx4 v246, s[28:31], s69 offen offset:2048 nt lds
    buffer_load_dwordx4 v246, s[28:31], s69 offen offset:3072 nt lds
    s_add_u32 s69, s69, s74
    s_waitcnt vmcnt(20)
    v_mov_b32 v24, 29
    s_mov_b64 exec, 1
    ds_max_u32 v12, v24
    s_mov_b64 exec, -1
    s_mov_b32 m0, 102400
    s_nop 0
    buffer_load_dwordx4 v246, s[28:31], s69 offen offset:0 nt lds
    buffer_load_dwordx4 v246, s[28:31], s69 offen offset:1024 nt lds
    buffer_load_dwordx4 v246, s[28:31], s69 offen offset:2048 nt lds
    buffer_load_dwordx4 v246, s[28:31], s69 offen offset:3072 nt lds
    s_add_u32 s69, s69, s74
    s_waitcnt vmcnt(20)
    s_mov_b32 m0, 106496
    s_nop 0
    buffer_load_dwordx4 v246, s[28:31], s69 offen offset:0 nt lds
    buffer_load_dwordx4 v246, s[28:31], s69 offen offset:1024 nt lds
    buffer_load_dwordx4 v246, s[28:31], s69 offen offset:2048 nt lds
    buffer_load_dwordx4 v246, s[28:31], s69 offen offset:3072 nt lds
    s_add_u32 s69, s69, s74
    s_waitcnt vmcnt(20)
    s_mov_b32 m0, 110592
    s_nop 0
    buffer_load_dwordx4 v246, s[28:31], s69 offen offset:0 nt lds
    buffer_load_dwordx4 v246, s[28:31], s69 offen offset:1024 nt lds
    buffer_load_dwordx4 v246, s[28:31], s69 offen offset:2048 nt lds
    buffer_load_dwordx4 v246, s[28:31], s69 offen offset:3072 nt lds
    s_add_u32 s69, s69, s74
    ds_read_b128 v[16:19], v12 offset:16
    s_waitcnt lgkmcnt(0)
    v_min3_u32 v16, v16, v17, v18
    s_nop 0
    v_readfirstlane_b32 s73, v16
    s_nop 0
    s_cmp_ge_u32 s73, 14
    s_cbranch_scc0 L_sfd31_slow
L_sfd31:
    s_add_u32 s76, s77, 2
    s_cmp_lt_u32 s73, s76
    s_cbranch_scc1 L_sfd31_nb
    s_mov_b32 s71, 31
    s_add_u32 s65, s77, 4
    s_min_u32 s65, s65, 17
    s_call_b64 s[92:93], L_hburst
    s_mov_b32 s77, 1000
L_sfd31_nb:
    s_waitcnt vmcnt(20)
    s_mov_b32 m0, 0
    s_nop 0
    buffer_load_dwordx4 v246, s[28:31], s69 offen offset:0 nt lds
    buffer_load_dwordx4 v246, s[28:31], s69 offen offset:1024 nt lds
    buffer_load_dwordx4 v246, s[28:31], s69 offen offset:2048 nt lds
    buffer_load_dwordx4 v246, s[28:31], s69 offen offset:3072 nt lds
    s_add_u32 s69, s69, s74
    s_waitcnt vmcnt(20)
    v_mov_b32 v24, 30
    s_mov_b64 exec, 1
    ds_max_u32 v12, v24
    s_mov_b64 exec, -1
    s_mov_b32 m0, 4096
    s_nop 0
    buffer_load_dwordx4 v246, s[28:31], s69 offen offset:0 nt lds
    buffer_load_dwordx4 v246, s[28:31], s69 offen offset:1024 nt lds
    buffer_load_dwordx4 v246, s[28:31], s69 offen offset:2048 nt lds
    buffer_load_dwordx4 v246, s[28:31], s69 offen offset:3072 nt lds
    s_add_u32 s69, s69, s74
    s_waitcnt vmcnt(20)
    s_mov_b32 m0, 8192
    s_nop 0
    buffer_load_dwordx4 v246, s[28:31], s69 offen offset:0 nt lds
    buffer_load_dwordx4 v246, s[28:31], s69 offen offset:1024 nt lds
    buffer_load_dwordx4 v246, s[28:31], s69 offen offset:2048 nt lds
    buffer_load_dwordx4 v246, s[28:31], s69 offen offset:3072 nt lds
    s_add_u32 s69, s69, s74
    s_waitcnt vmcnt(20)
    s_mov_b32 m0, 12288
    s_nop 0
    buffer_load_dwordx4 v246, s[28:31], s69 offen offset:0 nt lds
    buffer_load_dwordx4 v246, s[28:31], s69 offen offset:1024 nt lds
    buffer_load_dwordx4 v246, s[28:31], s69 offen offset:2048 nt lds
    buffer_load_dwordx4 v246, s[28:31], s69 offen offset:3072 nt lds
    s_add_u32 s69, s69, s74
    s_waitcnt vmcnt(16)
    v_mov_b32 v24, 31
    s_mov_b64 exec, 1
    ds_max_u32 v12, v24
    s_mov_b64 exec, -1
    s_waitcnt vmcnt(0)
    v_mov_b32 v24, 32
    s_mov_b64 exec, 1
    ds_max_u32 v12, v24
    s_mov_b64 exec, -1
    ds_read_b128 v[16:19], v12 offset:16
    s_waitcnt lgkmcnt(0)
    v_min3_u32 v16, v16, v17, v18
    s_nop 0
    v_readfirstlane_b32 s73, v16
    s_nop 0
    s_cmp_ge_u32 s73, 100
    s_cbranch_scc0 L_sfend_slow
L_sfend:
    s_add_u32 s76, s77, 2
    s_cmp_lt_u32 s73, s76
    s_cbranch_scc1 L_sfend_nb
    s_call_b64 s[94:95], L_wburst
    s_mov_b32 s77, 1000
L_sfend_nb:
    ds_read_b32 v25, v12 offset:48
    s_waitcnt lgkmcnt(0)
    v_readfirstlane_b32 s78, v25
    s_lshl_b32 s73, s61, 5
    s_lshl_b32 s76, s3, 3
    s_add_u32 s73, s73, s76
    s_lshl_b32 s73, s73, 4
    s_add_u32 s73, s73, 12582912
    s_add_u32 s88, s18, s73
    s_addc_u32 s89, s19, 0
    s_movk_i32 s90, 128
    s_mov_b32 s91, 0x20000
    v_and_b32 v253, 7, v0
    v_lshlrev_b32 v253, 4, v253
    s_mov_b32 s71, 0
    s_mov_b32 s66, 0
    s_branch L_consume
L_sfc3_slow:
L_sfc3_spin:
    ds_read_b128 v[16:19], v12 offset:16
    s_waitcnt lgkmcnt(0)
    v_min3_u32 v16, v16, v17, v18
    s_nop 0
    v_readfirstlane_b32 s73, v16
    s_nop 0
    s_cmp_ge_u32 s73, 1
    s_cbranch_scc1 L_sfc3
    s_sub_u32 s72, s72, 1
    s_cbranch_scc1 L_sfc3_gu
    s_sleep 1
    s_branch L_sfc3_spin
L_sfc3_gu:
    s_mov_b32 s72, 0
    s_branch L_sfc3
L_sfc8_slow:
L_sfc8_spin:
    ds_read_b128 v[16:19], v12 offset:16
    s_waitcnt lgkmcnt(0)
    v_min3_u32 v16, v16, v17, v18
    s_nop 0
    v_readfirstlane_b32 s73, v16
    s_nop 0
    s_cmp_ge_u32 s73, 2
    s_cbranch_scc1 L_sfc8
    s_sub_u32 s72, s72, 1
    s_cbranch_scc1 L_sfc8_gu
    s_sleep 1
    s_branch L_sfc8_spin
L_sfc8_gu:
    s_mov_b32 s72, 0
    s_branch L_sfc8
L_sfc9_slow:
L_sfc9_spin:
    ds_read_b128 v[16:19], v12 offset:16
    s_waitcnt lgkmcnt(0)
    v_min3_u32 v16, v16, v17, v18
    s_nop 0
    v_readfirstlane_b32 s73, v16
    s_nop 0
    s_cmp_ge_u32 s73, 3
    s_cbranch_scc1 L_sfc9
    s_sub_u32 s72, s72, 1
    s_cbranch_scc1 L_sfc9_gu
    s_sleep 1
    s_branch L_sfc9_spin
L_sfc9_gu:
    s_mov_b32 s72, 0
    s_branch L_sfc9
L_sfc11_slow:
L_sfc11_spin:
    ds_read_b128 v[16:19], v12 offset:16
    s_waitcnt lgkmcnt(0)
    v_min3_u32 v16, v16, v17, v18
    s_nop 0
    v_readfirstlane_b32 s73, v16
    s_nop 0
    s_cmp_ge_u32 s73, 4
    s_cbranch_scc1 L_sfc11
    s_sub_u32 s72, s72, 1
    s_cbranch_scc1 L_sfc11_gu
    s_sleep 1
    s_branch L_sfc11_spin
L_sfc11_gu:
    s_mov_b32 s72, 0
    s_branch L_sfc11
L_sfd13_slow:
    s_waitcnt vmcnt(0)
    v_mov_b32 v24, 13
    s_mov_b64 exec, 1
    ds_max_u32 v12, v24
    s_mov_b64 exec, -1
L_sfd13_spin:
    ds_read_b128 v[16:19], v12 offset:16
    s_waitcnt lgkmcnt(0)
    v_min3_u32 v16, v16, v17, v18
    s_nop 0
    v_readfirstlane_b32 s73, v16
    s_nop 0
    s_cmp_ge_u32 s73, 5
    s_cbranch_scc1 L_sfd13
    s_sub_u32 s72, s72, 1
    s_cbranch_scc1 L_sfd13_gu
    s_sleep 1
    s_branch L_sfd13_spin
L_sfd13_gu:
    s_mov_b32 s72, 0
    s_branch L_sfd13
L_sfd15_slow:
    s_waitcnt vmcnt(16)
    v_mov_b32 v24, 14
    s_mov_b64 exec, 1
    ds_max_u32 v12, v24
    s_mov_b64 exec, -1
    ds_read_b128 v[16:19], v12 offset:16
    s_waitcnt lgkmcnt(0)
    v_min3_u32 v16, v16, v17, v18
    s_nop 0
    v_readfirstlane_b32 s73, v16
    s_nop 0
    s_cmp_ge_u32 s73, 6
    s_cbranch_scc1 L_sfd15
    s_waitcnt vmcnt(0)
    v_mov_b32 v24, 15
    s_mov_b64 exec, 1
    ds_max_u32 v12, v24
    s_mov_b64 exec, -1
L_sfd15_spin:
    ds_read_b128 v[16:19], v12 offset:16
    s_waitcnt lgkmcnt(0)
    v_min3_u32 v16, v16, v17, v18
    s_nop 0
    v_readfirstlane_b32 s73, v16
    s_nop 0
    s_cmp_ge_u32 s73, 6
    s_cbranch_scc1 L_sfd15
    s_sub_u32 s72, s72, 1
    s_cbranch_scc1 L_sfd15_gu
    s_sleep 1
    s_branch L_sfd15_spin
L_sfd15_gu:
    s_mov_b32 s72, 0
    s_branch L_sfd15
L_sfd17_slow:
    s_waitcnt vmcnt(16)
    v_mov_b32 v24, 16
    s_mov_b64 exec, 1
    ds_max_u32 v12, v24
    s_mov_b64 exec, -1
    ds_read_b128 v[16:19], v12 offset:16
    s_waitcnt lgkmcnt(0)
    v_min3_u32 v16, v16, v17, v18
    s_nop 0
    v_readfirstlane_b32 s73, v16
    s_nop 0
    s_cmp_ge_u32 s73, 7
    s_cbranch_scc1 L_sfd17
    s_waitcnt vmcnt(0)
    v_mov_b32 v24, 17
    s_mov_b64 exec, 1
    ds_max_u32 v12, v24
    s_mov_b64 exec, -1
L_sfd17_spin:
    ds_read_b128 v[16:19], v12 offset:16
    s_waitcnt lgkmcnt(0)
    v_min3_u32 v16, v16, v17, v18
    s_nop 0
    v_readfirstlane_b32 s73, v16
    s_nop 0
    s_cmp_ge_u32 s73, 7
    s_cbranch_scc1 L_sfd17
    s_sub_u32 s72, s72, 1
    s_cbranch_scc1 L_sfd17_gu
    s_sleep 1
    s_branch L_sfd17_spin
L_sfd17_gu:
    s_mov_b32 s72, 0
    s_branch L_sfd17
L_sfd19_slow:
    s_waitcnt vmcnt(16)
    v_mov_b32 v24, 18
    s_mov_b64 exec, 1
    ds_max_u32 v12, v24
    s_mov_b64 exec, -1
    ds_read_b128 v[16:19], v12 offset:16
    s_waitcnt lgkmcnt(0)
    v_min3_u32 v16, v16, v17, v18
    s_nop 0
    v_readfirstlane_b32 s73, v16
    s_nop 0
    s_cmp_ge_u32 s73, 8
    s_cbranch_scc1 L_sfd19
    s_waitcnt vmcnt(0)
    v_mov_b32 v24, 19
    s_mov_b64 exec, 1
    ds_max_u32 v12, v24
    s_mov_b64 exec, -1
L_sfd19_spin:
    ds_read_b128 v[16:19], v12 offset:16
    s_waitcnt lgkmcnt(0)
    v_min3_u32 v16, v16, v17, v18
    s_nop 0
    v_readfirstlane_b32 s73, v16
    s_nop 0
    s_cmp_ge_u32 s73, 8
    s_cbranch_scc1 L_sfd19
    s_sub_u32 s72, s72, 1
    s_cbranch_scc1 L_sfd19_gu
    s_sleep 1
    s_branch L_sfd19_spin
L_sfd19_gu:
    s_mov_b32 s72, 0
    s_branch L_sfd19
L_sfd21_slow:
    s_waitcnt vmcnt(16)
    v_mov_b32 v24, 20
    s_mov_b64 exec, 1
    ds_max_u32 v12, v24
    s_mov_b64 exec, -1
    ds_read_b128 v[16:19], v12 offset:16
    s_waitcnt lgkmcnt(0)
    v_min3_u32 v16, v16, v17, v18
    s_nop 0
    v_readfirstlane_b32 s73, v16
    s_nop 0
    s_cmp_ge_u32 s73, 9
    s_cbranch_scc1 L_sfd21
    s_waitcnt vmcnt(0)
    v_mov_b32 v24, 21
    s_mov_b64 exec, 1
    ds_max_u32 v12, v24
    s_mov_b64 exec, -1
L_sfd21_spin:
    ds_read_b128 v[16:19], v12 offset:16
    s_waitcnt lgkmcnt(0)
    v_min3_u32 v16, v16, v17, v18
    s_nop 0
    v_readfirstlane_b32 s73, v16
    s_nop 0
    s_cmp_ge_u32 s73, 9
    s_cbranch_scc1 L_sfd21
    s_sub_u32 s72, s72, 1
    s_cbranch_scc1 L_sfd21_gu
    s_sleep 1
    s_branch L_sfd21_spin
L_sfd21_gu:
    s_mov_b32 s72, 0
    s_branch L_sfd21
L_sfd23_slow:
    s_waitcnt vmcnt(16)
    v_mov_b32 v24, 22
    s_mov_b64 exec, 1
    ds_max_u32 v12, v24
    s_mov_b64 exec, -1
    ds_read_b128 v[16:19], v12 offset:16
    s_waitcnt lgkmcnt(0)
    v_min3_u32 v16, v16, v17, v18
    s_nop 0
    v_readfirstlane_b32 s73, v16
    s_nop 0
    s_cmp_ge_u32 s73, 10
    s_cbranch_scc1 L_sfd23
    s_waitcnt vmcnt(0)
    v_mov_b32 v24, 23
    s_mov_b64 exec, 1
    ds_max_u32 v12, v24
    s_mov_b64 exec, -1
L_sfd23_spin:
    ds_read_b128 v[16:19], v12 offset:16
    s_waitcnt lgkmcnt(0)
    v_min3_u32 v16, v16, v17, v18
    s_nop 0
    v_readfirstlane_b32 s73, v16
    s_nop 0
    s_cmp_ge_u32 s73, 10
    s_cbranch_scc1 L_sfd23
    s_sub_u32 s72, s72, 1
    s_cbranch_scc1 L_sfd23_gu
    s_sleep 1
    s_branch L_sfd23_spin
L_sfd23_gu:
    s_mov_b32 s72, 0
    s_branch L_sfd23
L_sfd25_slow:
    s_waitcnt vmcnt(16)
    v_mov_b32 v24, 24
    s_mov_b64 exec, 1
    ds_max_u32 v12, v24
    s_mov_b64 exec, -1
    ds_read_b128 v[16:19], v12 offset:16
    s_waitcnt lgkmcnt(0)
    v_min3_u32 v16, v16, v17, v18
    s_nop 0
    v_readfirstlane_b32 s73, v16
    s_nop 0
    s_cmp_ge_u32 s73, 11
    s_cbranch_scc1 L_sfd25
    s_waitcnt vmcnt(0)
    v_mov_b32 v24, 25
    s_mov_b64 exec, 1
    ds_max_u32 v12, v24
    s_mov_b64 exec, -1
L_sfd25_spin:
    ds_read_b128 v[16:19], v12 offset:16
    s_waitcnt lgkmcnt(0)
    v_min3_u32 v16, v16, v17, v18
    s_nop 0
    v_readfirstlane_b32 s73, v16
    s_nop 0
    s_cmp_ge_u32 s73, 11
    s_cbranch_scc1 L_sfd25
    s_sub_u32 s72, s72, 1
    s_cbranch_scc1 L_sfd25_gu
    s_sleep 1
    s_branch L_sfd25_spin
L_sfd25_gu:
    s_mov_b32 s72, 0
    s_branch L_sfd25
L_sfd27_slow:
    s_waitcnt vmcnt(16)
    v_mov_b32 v24, 26
    s_mov_b64 exec, 1
    ds_max_u32 v12, v24
    s_mov_b64 exec, -1
    ds_read_b128 v[16:19], v12 offset:16
    s_waitcnt lgkmcnt(0)
    v_min3_u32 v16, v16, v17, v18
    s_nop 0
    v_readfirstlane_b32 s73, v16
    s_nop 0
    s_cmp_ge_u32 s73, 12
    s_cbranch_scc1 L_sfd27
    s_waitcnt vmcnt(0)
    v_mov_b32 v24, 27
    s_mov_b64 exec, 1
    ds_max_u32 v12, v24
    s_mov_b64 exec, -1
L_sfd27_spin:
    ds_read_b128 v[16:19], v12 offset:16
    s_waitcnt lgkmcnt(0)
    v_min3_u32 v16, v16, v17, v18
    s_nop 0
    v_readfirstlane_b32 s73, v16
    s_nop 0
    s_cmp_ge_u32 s73, 12
    s_cbranch_scc1 L_sfd27
    s_sub_u32 s72, s72, 1
    s_cbranch_scc1 L_sfd27_gu
    s_sleep 1
    s_branch L_sfd27_spin
L_sfd27_gu:
    s_mov_b32 s72, 0
    s_branch L_sfd27
L_sfd29_slow:
    s_waitcnt vmcnt(16)
    v_mov_b32 v24, 28
    s_mov_b64 exec, 1
    ds_max_u32 v12, v24
    s_mov_b64 exec, -1
    ds_read_b128 v[16:19], v12 offset:16
    s_waitcnt lgkmcnt(0)
    v_min3_u32 v16, v16, v17, v18
    s_nop 0
    v_readfirstlane_b32 s73, v16
    s_nop 0
    s_cmp_ge_u32 s73, 13
    s_cbranch_scc1 L_sfd29
    s_waitcnt vmcnt(0)
    v_mov_b32 v24, 29
    s_mov_b64 exec, 1
    ds_max_u32 v12, v24
    s_mov_b64 exec, -1
L_sfd29_spin:
    ds_read_b128 v[16:19], v12 offset:16
    s_waitcnt lgkmcnt(0)
    v_min3_u32 v16, v16, v17, v18
    s_nop 0
    v_readfirstlane_b32 s73, v16
    s_nop 0
    s_cmp_ge_u32 s73, 13
    s_cbranch_scc1 L_sfd29
    s_sub_u32 s72, s72, 1
    s_cbranch_scc1 L_sfd29_gu
    s_sleep 1
    s_branch L_sfd29_spin
L_sfd29_gu:
    s_mov_b32 s72, 0
    s_branch L_sfd29
L_sfd31_slow:
    s_waitcnt vmcnt(16)
    v_mov_b32 v24, 30
    s_mov_b64 exec, 1
    ds_max_u32 v12, v24
    s_mov_b64 exec, -1
    ds_read_b128 v[16:19], v12 offset:16
    s_waitcnt lgkmcnt(0)
    v_min3_u32 v16, v16, v17, v18
    s_nop 0
    v_readfirstlane_b32 s73, v16
    s_nop 0
    s_cmp_ge_u32 s73, 14
    s_cbranch_scc1 L_sfd31
    s_waitcnt vmcnt(0)
    v_mov_b32 v24, 31
    s_mov_b64 exec, 1
    ds_max_u32 v12, v24
    s_mov_b64 exec, -1
L_sfd31_spin:
    ds_read_b128 v[16:19], v12 offset:16
    s_waitcnt lgkmcnt(0)
    v_min3_u32 v16, v16, v17, v18
    s_nop 0
    v_readfirstlane_b32 s73, v16
    s_nop 0
    s_cmp_ge_u32 s73, 14
    s_cbranch_scc1 L_sfd31
    s_sub_u32 s72, s72, 1
    s_cbranch_scc1 L_sfd31_gu
    s_sleep 1
    s_branch L_sfd31_spin
L_sfd31_gu:
    s_mov_b32 s72, 0
    s_branch L_sfd31
L_sfend_slow:
L_sfend_spin:
    ds_read_b128 v[16:19], v12 offset:16
    s_waitcnt lgkmcnt(0)
    v_min3_u32 v16, v16, v17, v18
    s_nop 0
    v_readfirstlane_b32 s73, v16
    s_nop 0
    s_cmp_ge_u32 s73, 100
    s_cbranch_scc1 L_sfend
    s_sub_u32 s72, s72, 1
    s_cbranch_scc1 L_sfend_gu
    s_sleep 1
    s_branch L_sfend_spin
L_sfend_gu:
    s_mov_b32 s72, 0
    s_branch L_sfend
L_code_end:
    s_endpgm
.section .rodata,"a"
.p2align 6
.amdhsa_kernel standalone__gqa_block_cached__near_ridge_kernel
  .amdhsa_next_free_vgpr 512
  .amdhsa_next_free_sgpr 102
  .amdhsa_accum_offset 256
  .amdhsa_group_segment_fixed_size 0
  .amdhsa_kernarg_size 64
  .amdhsa_user_sgpr_count 2
  .amdhsa_user_sgpr_kernarg_segment_ptr 1
  .amdhsa_system_sgpr_workgroup_id_x 1
.end_amdhsa_kernel
```
